```python
import torch

def _softmax(x, axis=-1):
    return torch.softmax(x, dim=axis)
def _gelu(x):
    return torch.nn.functional.gelu(x, approximate="tanh")
def _silu(x):
    return torch.nn.functional.silu(x)
def _sigmoid(x):
    return torch.sigmoid(x)
def _layernorm(x, axis=-1, eps=1e-5):
    m = x.mean(dim=axis, keepdim=True)
    v = x.var(dim=axis, keepdim=True, unbiased=False)
    return (x - m) / torch.sqrt(v + eps)
def _scatter_add(tgt, idx, src, axis=0):
    return tgt.clone().index_add_(axis, idx, src)
def _segment_sum(src, seg, n):
    out = torch.zeros((n,) + src.shape[1:], dtype=src.dtype)
    return out.index_add_(0, seg, src)
def _pad(x, pw):
    flat = tuple(v for pair in reversed(pw) for v in pair)
    return torch.nn.functional.pad(x, flat)

kernel_name = 'gated_mix__mha_block__sliding_block__prompt'

def setup_inputs():

    _w = (lambda a: (lambda t: t.to(torch.bfloat16) if t.is_floating_point() else t)(torch.as_tensor(a)))
    def _A_setup():
        B, S, D, H = 1, 2048, 512, 32
        return {
            "x": _w((lambda *s: torch.randn(*s, dtype=torch.bfloat16) * 0.05)(B, S, D)),
            "wqkv": _w((lambda *s: torch.randn(*s, dtype=torch.bfloat16) * 1.6)(D, 3 * D)),
            "wo": _w((lambda *s: torch.randn(*s, dtype=torch.bfloat16) * 0.1)(D, D)),
        }
    _A_in = _A_setup()

    def _B_setup():
        B, S, D = 1, 2048, 512
        return {
            "x": _w((lambda *s: torch.randn(*s, dtype=torch.bfloat16) * 0.05)(B, S, D)),
            "wqkv": _w((lambda *s: torch.randn(*s, dtype=torch.bfloat16) * 1.6)(D, 3 * D)),
            "wo": _w((lambda *s: torch.randn(*s, dtype=torch.bfloat16) * 0.05)(D, D)),
        }
    _B_in = _B_setup()

    return {
        "A_x": _A_in["x"],
        "A_wqkv": _A_in["wqkv"],
        "A_wo": _A_in["wo"],
        "B_x": _B_in["x"],
        "B_wqkv": _B_in["wqkv"],
        "B_wo": _B_in["wo"],
        "gate_w": _w((lambda *s: torch.randn(*s, dtype=torch.bfloat16) * 0.05)(512) * 16.0),
    }

def reference(A_x, A_wqkv, A_wo, B_x, B_wqkv, B_wo, gate_w):
    def _A_ref(x, wqkv, wo):
        B, S, D = x.shape
        H = 32
        Dh = D // H
        qkv = (lambda x, *d: x.permute(*d))((x @ wqkv).reshape(B, S, 3, H, Dh), 2, 0, 3, 1, 4)
        q, k, v = qkv[0], qkv[1], qkv[2]
        scores = torch.einsum("bhqd,bhkd->bhqk", q, k) * (Dh ** -0.5)
        p = _softmax(scores, axis=-1)
        o = torch.einsum("bhqk,bhkd->bhqd", p, v)
        return (lambda x, *d: x.permute(*d))(o, 0, 2, 1, 3).reshape(B, S, D) @ wo

    def _B_ref(x, wqkv, wo):
        B, S, D = x.shape
        H = 32; Dh = D // H; W = 256
        qkv = (lambda x, *d: x.permute(*d))((x @ wqkv).reshape(B, S, 3, H, Dh), 2, 0, 3, 1, 4)
        q, k, v = qkv[0], qkv[1], qkv[2]
        scores = torch.einsum("bhqd,bhkd->bhqk", q, k) * (Dh ** -0.5)
        idx = torch.arange(S)
        mask = (idx[:, None] - idx[None, :] >= 0) & (idx[:, None] - idx[None, :] < W)
        scores = torch.where(mask[None, None], scores, -1e9)
        p = _softmax(scores, axis=-1)
        o = torch.einsum("bhqk,bhkd->bhqd", p, v)
        return (lambda x, *d: x.permute(*d))(o, 0, 2, 1, 3).reshape(B, S, D) @ wo

    x = A_x
    g = _sigmoid((x * gate_w).sum(-1, keepdims=True))
    a = _A_ref(x, A_wqkv, A_wo)
    b = _B_ref(x, B_wqkv, B_wo)
    return g * a + (1 - g) * b
```

```asm
; @launch grid=(256,1,1) block=(512,1,1) lds=163840
.amdgcn_target "amdgcn-amd-amdhsa--gfx950"
.text
.globl gated_mix__mha_block__sliding_block__prompt_kernel
.p2align 8
.type gated_mix__mha_block__sliding_block__prompt_kernel,@function
gated_mix__mha_block__sliding_block__prompt_kernel:
    s_load_dwordx16 s[16:31], s[0:1], 0
    s_load_dwordx4 s[32:35], s[0:1], 64
    s_cmp_ge_u32 s2, 256
    s_cbranch_scc1 L_end
    v_lshrrev_b32 v1, 6, v0
    s_and_b32 s4, s2, 7
    v_readfirstlane_b32 s3, v1
    s_lshr_b32 s5, s2, 3
    s_cmp_lg_u32 s3, 7
    s_cbranch_scc1 L_nocpf
    s_cmp_ge_u32 s5, 12
    s_cbranch_scc1 L_nocpf
    s_getpc_b64 s[76:77]
    v_and_b32 v4, 15, v0
    s_mul_i32 s6, s5, 2048
    v_lshl_add_u32 v4, v4, 7, s6
    v_min_u32 v4, L_code_end-L_cpf_base-4, v4
L_cpf_base:
    global_load_dword v29, v4, s[76:77]
L_nocpf:
    v_lshrrev_b32 v4, 3, v0
    s_lshr_b32 s69, s5, 1
    v_bfe_u32 v5, v0, 4, 3
    s_and_b32 s70, s5, 1
    v_and_b32 v6, 7, v0
    s_lshl_b32 s7, s70, 2
    v_xor_b32 v5, v5, v6
    s_add_u32 s7, s7, s69
    v_lshlrev_b32 v5, 4, v5
    s_add_u32 s7, s7, s4
    v_lshl_add_u32 v2, v4, 10, v5
    s_lshl_b32 s65, s7, 7
    s_lshl_b32 s6, s69, 17
    v_add_u32 v2, s6, v2
    s_lshl_b32 s66, s3, 10
    v_lshrrev_b32 v5, 2, v0
    s_mov_b32 s14, 2097152
    v_and_b32 v5, 4, v5
    s_mov_b32 s15, 0x20000
    v_xor_b32 v5, v5, v6
    s_lshl_b32 s71, s4, 7
    v_lshlrev_b32 v5, 4, v5
    s_lshl_b32 s72, s70, 10
    v_mul_u32_u24 v3, 3072, v4
    s_xor_b32 s73, s72, 1024
    v_add_u32 v3, v3, v5
    s_add_u32 s73, s73, s71
    s_add_u32 s74, s71, 2048
    s_sub_u32 s38, 1572864, s73
    s_mov_b32 s39, 0x20000
    s_sub_u32 s42, 1572864, s74
    s_mov_b32 s43, 0x20000
    s_add_u32 s62, s65, 0
    s_and_b32 s62, s62, 0x3ff
    s_mul_i32 s63, s62, 1536
    s_add_u32 m0, s66, 0
    s_waitcnt lgkmcnt(0)
    s_mov_b32 s12, s16
    s_mov_b32 s13, s17
    buffer_load_dwordx4 v2, s[12:15], s62 offen lds
    s_add_u32 m0, s66, 8192
    s_add_u32 s6, s62, 65536
    buffer_load_dwordx4 v2, s[12:15], s6 offen lds
    s_add_u32 s36, s18, s73
    s_addc_u32 s37, s19, 0
    s_add_u32 m0, s66, 16384
    s_nop 0
    buffer_load_dwordx4 v3, s[36:39], s63 offen lds
    s_cmp_eq_u32 s70, 0
    s_cselect_b32 s40, s18, s24
    s_cselect_b32 s41, s19, s25
    s_add_u32 s40, s40, s74
    s_addc_u32 s41, s41, 0
    s_add_u32 m0, s66, 24576
    s_nop 0
    buffer_load_dwordx4 v3, s[40:43], s63 offen lds
    s_add_u32 s76, s34, 16842752
    s_addc_u32 s77, s35, 0
    s_load_dword s85, s[76:77], 0
    s_barrier
    s_add_u32 s62, s65, 128
    s_and_b32 s62, s62, 0x3ff
    s_mul_i32 s63, s62, 1536
    s_add_u32 m0, s66, 32768
    s_nop 0
    buffer_load_dwordx4 v2, s[12:15], s62 offen lds
    s_add_u32 m0, s66, 49152
    s_nop 0
    buffer_load_dwordx4 v3, s[36:39], s63 offen lds
    s_add_u32 m0, s66, 40960
    s_add_u32 s6, s62, 65536
    buffer_load_dwordx4 v2, s[12:15], s6 offen lds
    s_add_u32 m0, s66, 57344
    s_nop 0
    buffer_load_dwordx4 v3, s[40:43], s63 offen lds
    v_and_b32 v1, 63, v0
    s_mov_b32 s64, s4
    s_and_b32 s67, s5, 3
    s_lshl_b32 s6, s4, 2
    s_add_u32 s67, s67, s6
    s_lshr_b32 s68, s5, 2
    s_add_u32 s72, s72, s71
    s_add_u32 s44, s24, s72
    s_addc_u32 s45, s25, 0
    s_sub_u32 s46, 1572864, s72
    s_mov_b32 s47, 0x20000
    s_mov_b32 s8, s34
    s_mov_b32 s9, s35
    s_mov_b32 s10, 268435456
    s_mov_b32 s11, 0x20000
    v_and_b32 v4, 0x13, v1
    v_and_b32 v5, 4, v1
    v_lshl_or_b32 v4, v5, 1, v4
    v_and_b32 v5, 8, v1
    v_lshrrev_b32 v5, 1, v5
    v_or_b32 v4, v4, v5
    v_lshrrev_b32 v5, 5, v1
    v_bfe_u32 v6, v4, 1, 3
    v_xor_b32 v6, v6, v5
    v_lshlrev_b32 v6, 4, v6
    v_lshl_add_u32 v6, v4, 7, v6
    s_and_b32 s6, s3, 3
    s_lshl_b32 s7, s6, 12
    v_add_u32 v16, s7, v6
    v_xor_b32 v17, 32, v16
    v_xor_b32 v18, 64, v16
    v_xor_b32 v19, 96, v16
    v_add_u32 v20, 65536, v16
    v_add_u32 v21, 65536, v17
    v_add_u32 v22, 65536, v18
    v_add_u32 v23, 65536, v19
    v_add_u32 v24, 131072, v16
    v_add_u32 v25, 131072, v17
    v_add_u32 v26, 131072, v18
    v_add_u32 v27, 131072, v19
    s_lshl_b32 s7, s69, 2
    s_add_u32 s7, s7, s6
    s_lshl_b32 s7, s7, 10
    s_lshr_b32 s6, s3, 2
    s_lshl_b32 s76, s6, 17
    s_add_u32 s7, s7, s76
    s_lshl_b32 s76, s64, 18
    s_add_u32 s7, s7, s76
    v_lshl_add_u32 v6, v5, 5, v4
    v_lshl_add_u32 v12, v6, 4, s7
    v_and_b32 v6, 15, v1
    v_lshlrev_b32 v6, 4, v6
    v_lshl_add_u32 v6, v5, 8, v6
    v_bfe_u32 v7, v1, 4, 1
    v_lshl_add_u32 v6, v7, 16, v6
    v_add_u32 v13, s7, v6
    v_bfe_u32 v4, v1, 2, 2
    v_lshl_add_u32 v6, v5, 3, v4
    v_lshlrev_b32 v6, 7, v6
    v_lshrrev_b32 v4, 1, v4
    v_xor_b32 v4, s6, v4
    v_lshl_add_u32 v6, v4, 6, v6
    v_lshl_add_u32 v6, v7, 5, v6
    v_and_b32 v4, 3, v1
    v_lshl_add_u32 v8, v4, 3, v6
    v_add_u32 v9, 0x10000, v8
    v_add_u32 v10, 0x20000, v8
    s_mov_b32 s76, 1052289595
    s_cmp_eq_u32 s70, 0
    s_cselect_b32 s78, 1.0, s76
    s_cselect_b32 s80, s76, 1.0
    s_mov_b32 s79, s78
    s_mov_b32 s81, s80
    s_cselect_b32 s82, 1, 0
    s_cselect_b32 s83, 2, 5
    s_cselect_b32 s84, 3, 4
    s_lshl_b32 s82, s82, 21
    s_lshl_b32 s83, s83, 21
    s_lshl_b32 s84, s84, 21
    s_lshl_b32 s71, s64, 13
    s_lshl_b32 s6, s69, 8
    s_add_u32 s71, s71, s6
    s_lshl_b32 s6, s70, 7
    s_add_u32 s71, s71, s6
    s_add_u32 s71, s71, 16908288
    v_lshlrev_b32 v14, 4, v1
    v_mov_b32 v100, 0xdddddddd
    v_lshlrev_b32 v15, 7, v1
    v_lshrrev_b32 v5, 5, v1
    v_and_b32 v6, 15, v1
    v_lshlrev_b32 v6, 4, v6
    v_lshl_add_u32 v6, v5, 8, v6
    v_add_u32 v102, 65536, v6
    s_add_u32 s6, s66, 131072
    v_add_u32 v108, s6, v14
    s_add_u32 s6, s66, 147456
    v_add_u32 v109, s6, v6
    v_and_b32 v4, 31, v1
    v_mov_b32 v111, 4286578688
    v_and_b32 v6, 27, v4
    v_cmp_eq_u32 vcc, 16, v6
    v_mov_b32 v6, 0x3f803f80
    s_nop 0
    v_cndmask_b32 v96, 0, v6, vcc
    v_mov_b32 v97, v96
    v_mov_b32 v98, v96
    v_mov_b32 v99, v96
    s_waitcnt vmcnt(4) lgkmcnt(0)
    s_barrier
    ds_read_b128 v[128:131], v16 offset:0
    ds_read_b64_tr_b16 v[32:33], v8 offset:16384
    ds_read_b64_tr_b16 v[34:35], v8 offset:16896
    ds_read_b64_tr_b16 v[36:37], v8 offset:24576
    ds_read_b64_tr_b16 v[38:39], v8 offset:25088
    ds_read_b128 v[132:135], v17 offset:0
    ds_read_b64_tr_b16 v[40:41], v8 offset:18432
    ds_read_b64_tr_b16 v[42:43], v8 offset:18944
    ds_read_b64_tr_b16 v[44:45], v8 offset:26624
    ds_read_b64_tr_b16 v[46:47], v8 offset:27136
    ds_read_b128 v[136:139], v18 offset:0
    ds_read_b64_tr_b16 v[48:49], v8 offset:20480
    ds_read_b64_tr_b16 v[50:51], v8 offset:20992
    ds_read_b64_tr_b16 v[52:53], v8 offset:28672
    ds_read_b64_tr_b16 v[54:55], v8 offset:29184
    ds_read_b128 v[140:143], v19 offset:0
    ds_read_b64_tr_b16 v[56:57], v8 offset:22528
    ds_read_b64_tr_b16 v[58:59], v8 offset:23040
    ds_read_b64_tr_b16 v[60:61], v8 offset:30720
    ds_read_b64_tr_b16 v[62:63], v8 offset:31232
    s_waitcnt lgkmcnt(15)
    v_mfma_f32_32x32x16_bf16 v[64:79], v[32:35], v[128:131], 0
    v_mfma_f32_32x32x16_bf16 v[80:95], v[128:131], v[36:39], 0
    s_add_u32 s62, s65, 256
    s_and_b32 s62, s62, 0x3ff
    s_mul_i32 s63, s62, 1536
    s_add_u32 m0, s66, 65536
    s_nop 0
    buffer_load_dwordx4 v2, s[12:15], s62 offen lds
    s_add_u32 m0, s66, 81920
    s_nop 0
    buffer_load_dwordx4 v3, s[36:39], s63 offen lds
    s_add_u32 s6, s71, 4096
    s_mov_b64 exec, 1
    buffer_load_dword v11, off, s[8:11], s6 sc1
    s_mov_b64 exec, -1
    s_waitcnt vmcnt(3)
    s_barrier
    ds_read_b128 v[144:147], v16 offset:32768
    ds_read_b64_tr_b16 v[32:33], v8 offset:49152
    ds_read_b64_tr_b16 v[34:35], v8 offset:49664
    ds_read_b64_tr_b16 v[36:37], v8 offset:57344
    ds_read_b64_tr_b16 v[38:39], v8 offset:57856
    s_waitcnt lgkmcnt(15)
    v_mfma_f32_32x32x16_bf16 v[64:79], v[40:43], v[132:135], v[64:79]
    v_mfma_f32_32x32x16_bf16 v[80:95], v[132:135], v[44:47], v[80:95]
    s_add_u32 m0, s66, 73728
    s_add_u32 s6, s62, 65536
    buffer_load_dwordx4 v2, s[12:15], s6 offen lds
    s_add_u32 m0, s66, 90112
    s_nop 0
    buffer_load_dwordx4 v3, s[40:43], s63 offen lds
    ds_read_b128 v[148:151], v17 offset:32768
    ds_read_b64_tr_b16 v[40:41], v8 offset:51200
    ds_read_b64_tr_b16 v[42:43], v8 offset:51712
    ds_read_b64_tr_b16 v[44:45], v8 offset:59392
    ds_read_b64_tr_b16 v[46:47], v8 offset:59904
    s_waitcnt lgkmcnt(15)
    v_mfma_f32_32x32x16_bf16 v[64:79], v[48:51], v[136:139], v[64:79]
    v_mfma_f32_32x32x16_bf16 v[80:95], v[136:139], v[52:55], v[80:95]
    s_add_u32 s62, s65, 384
    s_and_b32 s62, s62, 0x3ff
    s_mul_i32 s63, s62, 1536
    s_add_u32 m0, s66, 98304
    s_nop 0
    buffer_load_dwordx4 v2, s[12:15], s62 offen lds
    s_add_u32 m0, s66, 114688
    s_nop 0
    buffer_load_dwordx4 v3, s[36:39], s63 offen lds
    ds_read_b128 v[152:155], v18 offset:32768
    ds_read_b64_tr_b16 v[48:49], v8 offset:53248
    ds_read_b64_tr_b16 v[50:51], v8 offset:53760
    ds_read_b64_tr_b16 v[52:53], v8 offset:61440
    ds_read_b64_tr_b16 v[54:55], v8 offset:61952
    s_waitcnt lgkmcnt(15)
    v_mfma_f32_32x32x16_bf16 v[64:79], v[56:59], v[140:143], v[64:79]
    v_mfma_f32_32x32x16_bf16 v[80:95], v[140:143], v[60:63], v[80:95]
    s_add_u32 m0, s66, 106496
    s_add_u32 s6, s62, 65536
    buffer_load_dwordx4 v2, s[12:15], s6 offen lds
    s_add_u32 m0, s66, 122880
    s_nop 0
    buffer_load_dwordx4 v3, s[40:43], s63 offen lds
    ds_read_b128 v[156:159], v19 offset:32768
    ds_read_b64_tr_b16 v[56:57], v8 offset:55296
    ds_read_b64_tr_b16 v[58:59], v8 offset:55808
    ds_read_b64_tr_b16 v[60:61], v8 offset:63488
    ds_read_b64_tr_b16 v[62:63], v8 offset:64000
    s_waitcnt lgkmcnt(15)
    v_mfma_f32_32x32x16_bf16 v[64:79], v[32:35], v[144:147], v[64:79]
    v_mfma_f32_32x32x16_bf16 v[80:95], v[144:147], v[36:39], v[80:95]
    s_add_u32 s62, s65, 512
    s_and_b32 s62, s62, 0x3ff
    s_mul_i32 s63, s62, 1536
    s_add_u32 m0, s66, 131072
    s_nop 0
    buffer_load_dwordx4 v2, s[12:15], s62 offen lds
    s_waitcnt vmcnt(5)
    s_barrier
    ds_read_b128 v[160:163], v20 offset:0
    ds_read_b64_tr_b16 v[32:33], v9 offset:16384
    ds_read_b64_tr_b16 v[34:35], v9 offset:16896
    ds_read_b64_tr_b16 v[36:37], v9 offset:24576
    ds_read_b64_tr_b16 v[38:39], v9 offset:25088
    s_waitcnt lgkmcnt(15)
    v_mfma_f32_32x32x16_bf16 v[64:79], v[40:43], v[148:151], v[64:79]
    v_mfma_f32_32x32x16_bf16 v[80:95], v[148:151], v[44:47], v[80:95]
    s_add_u32 m0, s66, 147456
    s_nop 0
    buffer_load_dwordx4 v3, s[36:39], s63 offen lds
    ds_read_b128 v[164:167], v21 offset:0
    ds_read_b64_tr_b16 v[40:41], v9 offset:18432
    ds_read_b64_tr_b16 v[42:43], v9 offset:18944
    ds_read_b64_tr_b16 v[44:45], v9 offset:26624
    ds_read_b64_tr_b16 v[46:47], v9 offset:27136
    s_waitcnt lgkmcnt(15)
    v_mfma_f32_32x32x16_bf16 v[64:79], v[48:51], v[152:155], v[64:79]
    v_mfma_f32_32x32x16_bf16 v[80:95], v[152:155], v[52:55], v[80:95]
    s_add_u32 m0, s66, 139264
    s_add_u32 s6, s62, 65536
    buffer_load_dwordx4 v2, s[12:15], s6 offen lds
    ds_read_b128 v[168:171], v22 offset:0
    ds_read_b64_tr_b16 v[48:49], v9 offset:20480
    ds_read_b64_tr_b16 v[50:51], v9 offset:20992
    ds_read_b64_tr_b16 v[52:53], v9 offset:28672
    ds_read_b64_tr_b16 v[54:55], v9 offset:29184
    s_waitcnt lgkmcnt(15)
    v_mfma_f32_32x32x16_bf16 v[64:79], v[56:59], v[156:159], v[64:79]
    v_mfma_f32_32x32x16_bf16 v[80:95], v[156:159], v[60:63], v[80:95]
    s_add_u32 m0, s66, 155648
    s_nop 0
    buffer_load_dwordx4 v3, s[40:43], s63 offen lds
    ds_read_b128 v[172:175], v23 offset:0
    ds_read_b64_tr_b16 v[56:57], v9 offset:22528
    ds_read_b64_tr_b16 v[58:59], v9 offset:23040
    ds_read_b64_tr_b16 v[60:61], v9 offset:30720
    ds_read_b64_tr_b16 v[62:63], v9 offset:31232
    s_waitcnt lgkmcnt(15)
    v_mfma_f32_32x32x16_bf16 v[64:79], v[32:35], v[160:163], v[64:79]
    v_mfma_f32_32x32x16_bf16 v[80:95], v[160:163], v[36:39], v[80:95]
    s_add_u32 s62, s65, 640
    s_and_b32 s62, s62, 0x3ff
    s_mul_i32 s63, s62, 1536
    s_add_u32 m0, s66, 0
    s_nop 0
    buffer_load_dwordx4 v2, s[12:15], s62 offen lds
    s_waitcnt vmcnt(5)
    s_barrier
    ds_read_b128 v[176:179], v20 offset:32768
    ds_read_b64_tr_b16 v[32:33], v9 offset:49152
    ds_read_b64_tr_b16 v[34:35], v9 offset:49664
    ds_read_b64_tr_b16 v[36:37], v9 offset:57344
    ds_read_b64_tr_b16 v[38:39], v9 offset:57856
    s_waitcnt lgkmcnt(15)
    v_mfma_f32_32x32x16_bf16 v[64:79], v[40:43], v[164:167], v[64:79]
    v_mfma_f32_32x32x16_bf16 v[80:95], v[164:167], v[44:47], v[80:95]
    s_add_u32 m0, s66, 16384
    s_nop 0
    buffer_load_dwordx4 v3, s[36:39], s63 offen lds
    ds_read_b128 v[180:183], v21 offset:32768
    ds_read_b64_tr_b16 v[40:41], v9 offset:51200
    ds_read_b64_tr_b16 v[42:43], v9 offset:51712
    ds_read_b64_tr_b16 v[44:45], v9 offset:59392
    ds_read_b64_tr_b16 v[46:47], v9 offset:59904
    s_waitcnt lgkmcnt(15)
    v_mfma_f32_32x32x16_bf16 v[64:79], v[48:51], v[168:171], v[64:79]
    v_mfma_f32_32x32x16_bf16 v[80:95], v[168:171], v[52:55], v[80:95]
    s_add_u32 m0, s66, 8192
    s_add_u32 s6, s62, 65536
    buffer_load_dwordx4 v2, s[12:15], s6 offen lds
    ds_read_b128 v[184:187], v22 offset:32768
    ds_read_b64_tr_b16 v[48:49], v9 offset:53248
    ds_read_b64_tr_b16 v[50:51], v9 offset:53760
    ds_read_b64_tr_b16 v[52:53], v9 offset:61440
    ds_read_b64_tr_b16 v[54:55], v9 offset:61952
    s_waitcnt lgkmcnt(15)
    v_mfma_f32_32x32x16_bf16 v[64:79], v[56:59], v[172:175], v[64:79]
    v_mfma_f32_32x32x16_bf16 v[80:95], v[172:175], v[60:63], v[80:95]
    s_add_u32 m0, s66, 24576
    s_nop 0
    buffer_load_dwordx4 v3, s[40:43], s63 offen lds
    ds_read_b128 v[188:191], v23 offset:32768
    ds_read_b64_tr_b16 v[56:57], v9 offset:55296
    ds_read_b64_tr_b16 v[58:59], v9 offset:55808
    ds_read_b64_tr_b16 v[60:61], v9 offset:63488
    ds_read_b64_tr_b16 v[62:63], v9 offset:64000
    s_waitcnt lgkmcnt(15)
    v_mfma_f32_32x32x16_bf16 v[64:79], v[32:35], v[176:179], v[64:79]
    v_mfma_f32_32x32x16_bf16 v[80:95], v[176:179], v[36:39], v[80:95]
    s_add_u32 s62, s65, 768
    s_and_b32 s62, s62, 0x3ff
    s_mul_i32 s63, s62, 1536
    s_add_u32 m0, s66, 32768
    s_nop 0
    buffer_load_dwordx4 v2, s[12:15], s62 offen lds
    s_waitcnt vmcnt(5)
    s_barrier
    ds_read_b128 v[192:195], v24 offset:0
    ds_read_b64_tr_b16 v[32:33], v10 offset:16384
    ds_read_b64_tr_b16 v[34:35], v10 offset:16896
    ds_read_b64_tr_b16 v[36:37], v10 offset:24576
    ds_read_b64_tr_b16 v[38:39], v10 offset:25088
    s_waitcnt lgkmcnt(15)
    v_mfma_f32_32x32x16_bf16 v[64:79], v[40:43], v[180:183], v[64:79]
    v_mfma_f32_32x32x16_bf16 v[80:95], v[180:183], v[44:47], v[80:95]
    s_add_u32 m0, s66, 49152
    s_nop 0
    buffer_load_dwordx4 v3, s[36:39], s63 offen lds
    ds_read_b128 v[196:199], v25 offset:0
    ds_read_b64_tr_b16 v[40:41], v10 offset:18432
    ds_read_b64_tr_b16 v[42:43], v10 offset:18944
    ds_read_b64_tr_b16 v[44:45], v10 offset:26624
    ds_read_b64_tr_b16 v[46:47], v10 offset:27136
    s_waitcnt lgkmcnt(15)
    v_mfma_f32_32x32x16_bf16 v[64:79], v[48:51], v[184:187], v[64:79]
    v_mfma_f32_32x32x16_bf16 v[80:95], v[184:187], v[52:55], v[80:95]
    s_add_u32 m0, s66, 40960
    s_add_u32 s6, s62, 65536
    buffer_load_dwordx4 v2, s[12:15], s6 offen lds
    ds_read_b128 v[200:203], v26 offset:0
    ds_read_b64_tr_b16 v[48:49], v10 offset:20480
    ds_read_b64_tr_b16 v[50:51], v10 offset:20992
    ds_read_b64_tr_b16 v[52:53], v10 offset:28672
    ds_read_b64_tr_b16 v[54:55], v10 offset:29184
    s_waitcnt lgkmcnt(15)
    v_mfma_f32_32x32x16_bf16 v[64:79], v[56:59], v[188:191], v[64:79]
    v_mfma_f32_32x32x16_bf16 v[80:95], v[188:191], v[60:63], v[80:95]
    s_add_u32 m0, s66, 57344
    s_nop 0
    buffer_load_dwordx4 v3, s[40:43], s63 offen lds
    ds_read_b128 v[204:207], v27 offset:0
    ds_read_b64_tr_b16 v[56:57], v10 offset:22528
    ds_read_b64_tr_b16 v[58:59], v10 offset:23040
    ds_read_b64_tr_b16 v[60:61], v10 offset:30720
    ds_read_b64_tr_b16 v[62:63], v10 offset:31232
    s_waitcnt lgkmcnt(15)
    v_mfma_f32_32x32x16_bf16 v[64:79], v[32:35], v[192:195], v[64:79]
    v_mfma_f32_32x32x16_bf16 v[80:95], v[192:195], v[36:39], v[80:95]
    s_add_u32 s62, s65, 896
    s_and_b32 s62, s62, 0x3ff
    s_mul_i32 s63, s62, 1536
    s_add_u32 m0, s66, 65536
    s_nop 0
    buffer_load_dwordx4 v2, s[12:15], s62 offen lds
    s_waitcnt vmcnt(5)
    s_barrier
    ds_read_b128 v[208:211], v16 offset:0
    ds_read_b64_tr_b16 v[32:33], v8 offset:16384
    ds_read_b64_tr_b16 v[34:35], v8 offset:16896
    ds_read_b64_tr_b16 v[36:37], v8 offset:24576
    ds_read_b64_tr_b16 v[38:39], v8 offset:25088
    s_waitcnt lgkmcnt(15)
    v_mfma_f32_32x32x16_bf16 v[64:79], v[40:43], v[196:199], v[64:79]
    v_mfma_f32_32x32x16_bf16 v[80:95], v[196:199], v[44:47], v[80:95]
    s_add_u32 m0, s66, 81920
    s_nop 0
    buffer_load_dwordx4 v3, s[36:39], s63 offen lds
    ds_read_b128 v[212:215], v17 offset:0
    ds_read_b64_tr_b16 v[40:41], v8 offset:18432
    ds_read_b64_tr_b16 v[42:43], v8 offset:18944
    ds_read_b64_tr_b16 v[44:45], v8 offset:26624
    ds_read_b64_tr_b16 v[46:47], v8 offset:27136
    s_waitcnt lgkmcnt(15)
    v_mfma_f32_32x32x16_bf16 v[64:79], v[48:51], v[200:203], v[64:79]
    v_mfma_f32_32x32x16_bf16 v[80:95], v[200:203], v[52:55], v[80:95]
    s_add_u32 m0, s66, 73728
    s_add_u32 s6, s62, 65536
    buffer_load_dwordx4 v2, s[12:15], s6 offen lds
    ds_read_b128 v[216:219], v18 offset:0
    ds_read_b64_tr_b16 v[48:49], v8 offset:20480
    ds_read_b64_tr_b16 v[50:51], v8 offset:20992
    ds_read_b64_tr_b16 v[52:53], v8 offset:28672
    ds_read_b64_tr_b16 v[54:55], v8 offset:29184
    s_waitcnt lgkmcnt(15)
    v_mfma_f32_32x32x16_bf16 v[64:79], v[56:59], v[204:207], v[64:79]
    v_mfma_f32_32x32x16_bf16 v[80:95], v[204:207], v[60:63], v[80:95]
    s_add_u32 m0, s66, 90112
    s_nop 0
    buffer_load_dwordx4 v3, s[40:43], s63 offen lds
    ds_read_b128 v[220:223], v19 offset:0
    ds_read_b64_tr_b16 v[56:57], v8 offset:22528
    ds_read_b64_tr_b16 v[58:59], v8 offset:23040
    ds_read_b64_tr_b16 v[60:61], v8 offset:30720
    ds_read_b64_tr_b16 v[62:63], v8 offset:31232
    s_waitcnt lgkmcnt(15)
    v_mfma_f32_32x32x16_bf16 v[64:79], v[32:35], v[208:211], v[64:79]
    v_mfma_f32_32x32x16_bf16 v[80:95], v[208:211], v[36:39], v[80:95]
    s_add_u32 m0, s66, 98304
    s_add_u32 s62, s65, 0
    s_and_b32 s62, s62, 0x3ff
    s_mul_i32 s63, s62, 1536
    buffer_load_dwordx4 v3, s[44:47], s63 offen lds
    s_waitcnt vmcnt(5)
    s_barrier
    ds_read_b128 v[224:227], v16 offset:32768
    ds_read_b64_tr_b16 v[32:33], v8 offset:49152
    ds_read_b64_tr_b16 v[34:35], v8 offset:49664
    ds_read_b64_tr_b16 v[36:37], v8 offset:57344
    ds_read_b64_tr_b16 v[38:39], v8 offset:57856
    s_waitcnt lgkmcnt(15)
    v_mfma_f32_32x32x16_bf16 v[64:79], v[40:43], v[212:215], v[64:79]
    v_mfma_f32_32x32x16_bf16 v[80:95], v[212:215], v[44:47], v[80:95]
    s_add_u32 m0, s66, 106496
    s_add_u32 s62, s65, 128
    s_and_b32 s62, s62, 0x3ff
    s_mul_i32 s63, s62, 1536
    buffer_load_dwordx4 v3, s[44:47], s63 offen lds
    ds_read_b128 v[228:231], v17 offset:32768
    ds_read_b64_tr_b16 v[40:41], v8 offset:51200
    ds_read_b64_tr_b16 v[42:43], v8 offset:51712
    ds_read_b64_tr_b16 v[44:45], v8 offset:59392
    ds_read_b64_tr_b16 v[46:47], v8 offset:59904
    s_waitcnt lgkmcnt(15)
    v_mfma_f32_32x32x16_bf16 v[64:79], v[48:51], v[216:219], v[64:79]
    v_mfma_f32_32x32x16_bf16 v[80:95], v[216:219], v[52:55], v[80:95]
    s_add_u32 m0, s66, 114688
    s_add_u32 s62, s65, 256
    s_and_b32 s62, s62, 0x3ff
    s_mul_i32 s63, s62, 1536
    buffer_load_dwordx4 v3, s[44:47], s63 offen lds
    ds_read_b128 v[232:235], v18 offset:32768
    ds_read_b64_tr_b16 v[48:49], v8 offset:53248
    ds_read_b64_tr_b16 v[50:51], v8 offset:53760
    ds_read_b64_tr_b16 v[52:53], v8 offset:61440
    ds_read_b64_tr_b16 v[54:55], v8 offset:61952
    s_waitcnt lgkmcnt(15)
    v_mfma_f32_32x32x16_bf16 v[64:79], v[56:59], v[220:223], v[64:79]
    v_mfma_f32_32x32x16_bf16 v[80:95], v[220:223], v[60:63], v[80:95]
    s_add_u32 m0, s66, 122880
    s_add_u32 s62, s65, 384
    s_and_b32 s62, s62, 0x3ff
    s_mul_i32 s63, s62, 1536
    buffer_load_dwordx4 v3, s[44:47], s63 offen lds
    ds_read_b128 v[236:239], v19 offset:32768
    ds_read_b64_tr_b16 v[56:57], v8 offset:55296
    ds_read_b64_tr_b16 v[58:59], v8 offset:55808
    ds_read_b64_tr_b16 v[60:61], v8 offset:63488
    ds_read_b64_tr_b16 v[62:63], v8 offset:64000
    s_waitcnt lgkmcnt(15)
    v_mfma_f32_32x32x16_bf16 v[64:79], v[32:35], v[224:227], v[64:79]
    v_mfma_f32_32x32x16_bf16 v[80:95], v[224:227], v[36:39], v[80:95]
    s_add_u32 m0, s66, 131072
    s_add_u32 s62, s65, 512
    s_and_b32 s62, s62, 0x3ff
    s_mul_i32 s63, s62, 1536
    buffer_load_dwordx4 v3, s[44:47], s63 offen lds
    s_waitcnt vmcnt(5)
    s_barrier
    ds_read_b128 v[240:243], v20 offset:0
    ds_read_b64_tr_b16 v[32:33], v9 offset:16384
    ds_read_b64_tr_b16 v[34:35], v9 offset:16896
    ds_read_b64_tr_b16 v[36:37], v9 offset:24576
    ds_read_b64_tr_b16 v[38:39], v9 offset:25088
    s_waitcnt lgkmcnt(15)
    v_mfma_f32_32x32x16_bf16 v[64:79], v[40:43], v[228:231], v[64:79]
    v_mfma_f32_32x32x16_bf16 v[80:95], v[228:231], v[44:47], v[80:95]
    s_add_u32 m0, s66, 139264
    s_add_u32 s62, s65, 640
    s_and_b32 s62, s62, 0x3ff
    s_mul_i32 s63, s62, 1536
    buffer_load_dwordx4 v3, s[44:47], s63 offen lds
    ds_read_b128 v[244:247], v21 offset:0
    ds_read_b64_tr_b16 v[40:41], v9 offset:18432
    ds_read_b64_tr_b16 v[42:43], v9 offset:18944
    ds_read_b64_tr_b16 v[44:45], v9 offset:26624
    ds_read_b64_tr_b16 v[46:47], v9 offset:27136
    s_waitcnt lgkmcnt(15)
    v_mfma_f32_32x32x16_bf16 v[64:79], v[48:51], v[232:235], v[64:79]
    v_mfma_f32_32x32x16_bf16 v[80:95], v[232:235], v[52:55], v[80:95]
    s_add_u32 m0, s66, 147456
    s_add_u32 s62, s65, 768
    s_and_b32 s62, s62, 0x3ff
    s_mul_i32 s63, s62, 1536
    buffer_load_dwordx4 v3, s[44:47], s63 offen lds
    ds_read_b128 v[248:251], v22 offset:0
    ds_read_b64_tr_b16 v[48:49], v9 offset:20480
    ds_read_b64_tr_b16 v[50:51], v9 offset:20992
    ds_read_b64_tr_b16 v[52:53], v9 offset:28672
    ds_read_b64_tr_b16 v[54:55], v9 offset:29184
    s_waitcnt lgkmcnt(15)
    v_mfma_f32_32x32x16_bf16 v[64:79], v[56:59], v[236:239], v[64:79]
    v_mfma_f32_32x32x16_bf16 v[80:95], v[236:239], v[60:63], v[80:95]
    s_add_u32 m0, s66, 155648
    s_add_u32 s62, s65, 896
    s_and_b32 s62, s62, 0x3ff
    s_mul_i32 s63, s62, 1536
    buffer_load_dwordx4 v3, s[44:47], s63 offen lds
    ds_read_b128 v[252:255], v23 offset:0
    ds_read_b64_tr_b16 v[56:57], v9 offset:22528
    ds_read_b64_tr_b16 v[58:59], v9 offset:23040
    ds_read_b64_tr_b16 v[60:61], v9 offset:30720
    ds_read_b64_tr_b16 v[62:63], v9 offset:31232
    s_waitcnt lgkmcnt(15)
    v_mfma_f32_32x32x16_bf16 v[64:79], v[32:35], v[240:243], v[64:79]
    v_mfma_f32_32x32x16_bf16 v[80:95], v[240:243], v[36:39], v[80:95]
    s_waitcnt lgkmcnt(10)
    v_mfma_f32_32x32x16_bf16 v[64:79], v[40:43], v[244:247], v[64:79]
    v_mfma_f32_32x32x16_bf16 v[80:95], v[244:247], v[44:47], v[80:95]
    s_waitcnt lgkmcnt(5)
    v_mfma_f32_32x32x16_bf16 v[64:79], v[48:51], v[248:251], v[64:79]
    v_mfma_f32_32x32x16_bf16 v[80:95], v[248:251], v[52:55], v[80:95]
    s_waitcnt lgkmcnt(0)
    v_mfma_f32_32x32x16_bf16 v[64:79], v[56:59], v[252:255], v[64:79]
    v_mfma_f32_32x32x16_bf16 v[80:95], v[252:255], v[60:63], v[80:95]
    s_mul_i32 s85, s85, 1664525
    s_add_u32 s85, s85, 1013904223
    s_cmp_eq_u32 s70, 0
    s_cselect_b32 s73, s83, 0x80000000
    s_cselect_b32 s83, 0x80000000, s83
    s_nop 5
    v_pk_mul_f32 v[64:65], v[64:65], s[78:79]
    v_pk_mul_f32 v[66:67], v[66:67], s[78:79]
    v_pk_mul_f32 v[68:69], v[68:69], s[78:79]
    v_pk_mul_f32 v[70:71], v[70:71], s[78:79]
    v_cvt_pk_bf16_f32 v48, v64, v65
    v_cvt_pk_bf16_f32 v49, v66, v67
    v_cvt_pk_bf16_f32 v50, v68, v69
    v_cvt_pk_bf16_f32 v51, v70, v71
    buffer_store_dwordx4 v[48:51], v12, s[8:11], s82 offen sc1
    v_pk_mul_f32 v[72:73], v[72:73], s[78:79]
    v_pk_mul_f32 v[74:75], v[74:75], s[78:79]
    v_pk_mul_f32 v[76:77], v[76:77], s[78:79]
    v_pk_mul_f32 v[78:79], v[78:79], s[78:79]
    v_cvt_pk_bf16_f32 v52, v72, v73
    v_cvt_pk_bf16_f32 v53, v74, v75
    v_cvt_pk_bf16_f32 v54, v76, v77
    v_cvt_pk_bf16_f32 v55, v78, v79
    s_add_u32 s7, s82, 65536
    buffer_store_dwordx4 v[52:55], v12, s[8:11], s7 offen sc1
    v_cvt_pk_bf16_f32 v120, v80, v81
    v_cvt_pk_bf16_f32 v121, v82, v83
    v_cvt_pk_bf16_f32 v122, v84, v85
    v_cvt_pk_bf16_f32 v123, v86, v87
    buffer_store_dwordx4 v[120:123], v13, s[8:11], s73 offen offset:0 sc1
    v_cvt_pk_bf16_f32 v124, v88, v89
    v_cvt_pk_bf16_f32 v125, v90, v91
    v_cvt_pk_bf16_f32 v126, v92, v93
    v_cvt_pk_bf16_f32 v127, v94, v95
    buffer_store_dwordx4 v[124:127], v13, s[8:11], s73 offen offset:512 sc1
    s_waitcnt vmcnt(8)
    s_barrier
    ds_read_b64_tr_b16 v[32:33], v9 offset:32768
    ds_read_b64_tr_b16 v[34:35], v9 offset:33280
    ds_read_b64_tr_b16 v[36:37], v9 offset:34816
    ds_read_b64_tr_b16 v[38:39], v9 offset:35328
    ds_read_b64_tr_b16 v[40:41], v9 offset:36864
    ds_read_b64_tr_b16 v[42:43], v9 offset:37376
    ds_read_b64_tr_b16 v[44:45], v9 offset:38912
    ds_read_b64_tr_b16 v[46:47], v9 offset:39424
    s_waitcnt lgkmcnt(6)
    v_mfma_f32_32x32x16_bf16 v[16:31], v[32:35], v[128:131], 0
    v_mov_b32 v64, 0
    v_mov_b32 v65, 0
    v_mov_b32 v66, 0
    v_mov_b32 v67, 0
    ds_read_b64_tr_b16 v[32:33], v9 offset:40960
    ds_read_b64_tr_b16 v[34:35], v9 offset:41472
    s_waitcnt lgkmcnt(6)
    v_mfma_f32_32x32x16_bf16 v[16:31], v[36:39], v[132:135], v[16:31]
    v_mov_b32 v68, 0
    v_mov_b32 v69, 0
    v_mov_b32 v70, 0
    v_mov_b32 v71, 0
    ds_read_b64_tr_b16 v[36:37], v9 offset:43008
    ds_read_b64_tr_b16 v[38:39], v9 offset:43520
    s_waitcnt lgkmcnt(6)
    v_mfma_f32_32x32x16_bf16 v[16:31], v[40:43], v[136:139], v[16:31]
    v_mov_b32 v72, 0
    v_mov_b32 v73, 0
    v_mov_b32 v74, 0
    v_mov_b32 v75, 0
    ds_read_b64_tr_b16 v[40:41], v9 offset:45056
    ds_read_b64_tr_b16 v[42:43], v9 offset:45568
    s_waitcnt lgkmcnt(6)
    v_mfma_f32_32x32x16_bf16 v[16:31], v[44:47], v[140:143], v[16:31]
    v_mov_b32 v76, 0
    v_mov_b32 v77, 0
    v_mov_b32 v78, 0
    v_mov_b32 v79, 0
    ds_read_b64_tr_b16 v[44:45], v9 offset:47104
    ds_read_b64_tr_b16 v[46:47], v9 offset:47616
    s_waitcnt lgkmcnt(6)
    v_mfma_f32_32x32x16_bf16 v[16:31], v[32:35], v[144:147], v[16:31]
    v_mov_b32 v88, v96
    v_mov_b32 v89, v96
    v_mov_b32 v90, v96
    v_mov_b32 v91, v96
    ds_read_b64_tr_b16 v[32:33], v9 offset:49152
    ds_read_b64_tr_b16 v[34:35], v9 offset:49664
    s_waitcnt lgkmcnt(6)
    v_mfma_f32_32x32x16_bf16 v[16:31], v[36:39], v[148:151], v[16:31]
    v_mov_b32 v92, v96
    v_mov_b32 v93, v96
    v_mov_b32 v94, v96
    v_mov_b32 v95, v96
    ds_read_b64_tr_b16 v[36:37], v9 offset:51200
    ds_read_b64_tr_b16 v[38:39], v9 offset:51712
    s_waitcnt lgkmcnt(6)
    v_mfma_f32_32x32x16_bf16 v[16:31], v[40:43], v[152:155], v[16:31]
    ds_read_b64_tr_b16 v[40:41], v9 offset:53248
    ds_read_b64_tr_b16 v[42:43], v9 offset:53760
    s_waitcnt lgkmcnt(6)
    v_mfma_f32_32x32x16_bf16 v[16:31], v[44:47], v[156:159], v[16:31]
    ds_read_b64_tr_b16 v[44:45], v9 offset:55296
    ds_read_b64_tr_b16 v[46:47], v9 offset:55808
    s_waitcnt lgkmcnt(6)
    v_mfma_f32_32x32x16_bf16 v[16:31], v[32:35], v[160:163], v[16:31]
    s_mov_b32 vcc_lo, 0xffffffff
    s_mov_b32 vcc_hi, 0xfffffff0
    v_cndmask_b32_e64 v128, v111, 0, vcc
    v_cndmask_b32 v144, 0, v111, vcc
    s_mov_b32 vcc_lo, 0xfffffffe
    s_mov_b32 vcc_hi, 0xffffffe0
    v_cndmask_b32_e64 v129, v111, 0, vcc
    v_cndmask_b32 v145, 0, v111, vcc
    ds_read_b64_tr_b16 v[32:33], v9 offset:57344
    ds_read_b64_tr_b16 v[34:35], v9 offset:57856
    s_waitcnt lgkmcnt(6)
    v_mfma_f32_32x32x16_bf16 v[16:31], v[36:39], v[164:167], v[16:31]
    s_mov_b32 vcc_lo, 0xfffffffc
    s_mov_b32 vcc_hi, 0xffffffc0
    v_cndmask_b32_e64 v130, v111, 0, vcc
    v_cndmask_b32 v146, 0, v111, vcc
    s_mov_b32 vcc_lo, 0xfffffff8
    s_mov_b32 vcc_hi, 0xffffff80
    v_cndmask_b32_e64 v131, v111, 0, vcc
    v_cndmask_b32 v147, 0, v111, vcc
    ds_read_b64_tr_b16 v[36:37], v9 offset:59392
    ds_read_b64_tr_b16 v[38:39], v9 offset:59904
    s_waitcnt lgkmcnt(6)
    v_mfma_f32_32x32x16_bf16 v[16:31], v[40:43], v[168:171], v[16:31]
    s_mov_b32 vcc_lo, 0xffffff00
    s_mov_b32 vcc_hi, 0xfffff000
    v_cndmask_b32_e64 v132, v111, 0, vcc
    v_cndmask_b32 v148, 0, v111, vcc
    s_mov_b32 vcc_lo, 0xfffffe00
    s_mov_b32 vcc_hi, 0xffffe000
    v_cndmask_b32_e64 v133, v111, 0, vcc
    v_cndmask_b32 v149, 0, v111, vcc
    ds_read_b64_tr_b16 v[40:41], v9 offset:61440
    ds_read_b64_tr_b16 v[42:43], v9 offset:61952
    s_waitcnt lgkmcnt(6)
    v_mfma_f32_32x32x16_bf16 v[16:31], v[44:47], v[172:175], v[16:31]
    s_mov_b32 vcc_lo, 0xfffffc00
    s_mov_b32 vcc_hi, 0xffffc000
    v_cndmask_b32_e64 v134, v111, 0, vcc
    v_cndmask_b32 v150, 0, v111, vcc
    s_mov_b32 vcc_lo, 0xfffff800
    s_mov_b32 vcc_hi, 0xffff8000
    v_cndmask_b32_e64 v135, v111, 0, vcc
    v_cndmask_b32 v151, 0, v111, vcc
    ds_read_b64_tr_b16 v[44:45], v9 offset:63488
    ds_read_b64_tr_b16 v[46:47], v9 offset:64000
    s_waitcnt lgkmcnt(6)
    v_mfma_f32_32x32x16_bf16 v[16:31], v[32:35], v[176:179], v[16:31]
    s_mov_b32 vcc_lo, 0xffff0000
    s_mov_b32 vcc_hi, 0xfff00000
    v_cndmask_b32_e64 v136, v111, 0, vcc
    v_cndmask_b32 v152, 0, v111, vcc
    s_mov_b32 vcc_lo, 0xfffe0000
    s_mov_b32 vcc_hi, 0xffe00000
    v_cndmask_b32_e64 v137, v111, 0, vcc
    v_cndmask_b32 v153, 0, v111, vcc
    s_waitcnt vmcnt(4)
    s_barrier
    ds_read_b64_tr_b16 v[32:33], v10 offset:0
    ds_read_b64_tr_b16 v[34:35], v10 offset:512
    s_waitcnt lgkmcnt(6)
    v_mfma_f32_32x32x16_bf16 v[16:31], v[36:39], v[180:183], v[16:31]
    s_mov_b32 vcc_lo, 0xfffc0000
    s_mov_b32 vcc_hi, 0xffc00000
    v_cndmask_b32_e64 v138, v111, 0, vcc
    v_cndmask_b32 v154, 0, v111, vcc
    s_mov_b32 vcc_lo, 0xfff80000
    s_mov_b32 vcc_hi, 0xff800000
    v_cndmask_b32_e64 v139, v111, 0, vcc
    v_cndmask_b32 v155, 0, v111, vcc
    ds_read_b64_tr_b16 v[36:37], v10 offset:2048
    ds_read_b64_tr_b16 v[38:39], v10 offset:2560
    s_waitcnt lgkmcnt(6)
    v_mfma_f32_32x32x16_bf16 v[16:31], v[40:43], v[184:187], v[16:31]
    s_mov_b32 vcc_lo, 0xff000000
    s_mov_b32 vcc_hi, 0xf0000000
    v_cndmask_b32_e64 v140, v111, 0, vcc
    v_cndmask_b32 v156, 0, v111, vcc
    s_mov_b32 vcc_lo, 0xfe000000
    s_mov_b32 vcc_hi, 0xe0000000
    v_cndmask_b32_e64 v141, v111, 0, vcc
    v_cndmask_b32 v157, 0, v111, vcc
    s_waitcnt vmcnt(0)
    s_barrier
    s_cmp_lg_u32 s3, 1
    s_cbranch_scc1 L_nofa
    v_mov_b32 v56, s85
    v_mov_b32 v57, s60
    v_mov_b32 v58, s85
    v_mov_b32 v59, s60
    s_mov_b64 exec, 0xff
    s_add_u32 s76, s71, 4096
    buffer_store_dwordx4 v[56:59], v14, s[8:11], s76 offen
    buffer_store_dwordx4 v[56:59], v14, s[8:11], s71 offen sc1
    s_mov_b64 exec, -1
L_nofa:
    s_mov_b32 s48, s28
    s_mov_b32 s49, s29
    s_mov_b32 s50, 1024
    s_mov_b32 s51, 0x20000
    s_lshl_b32 s76, s68, 3
    s_add_u32 s76, s76, s3
    s_lshl_b32 s76, s76, 5
    s_add_u32 s75, s76, s67
    s_lshl_b32 s76, s75, 10
    buffer_load_dwordx4 v[112:115], v14, s[12:15], s76 offen
    buffer_load_dwordx4 v[116:119], v14, s[48:51], 0 offen
    ds_read_b64_tr_b16 v[40:41], v10 offset:4096
    ds_read_b64_tr_b16 v[42:43], v10 offset:4608
    s_waitcnt lgkmcnt(6)
    v_mfma_f32_32x32x16_bf16 v[16:31], v[44:47], v[188:191], v[16:31]
    s_mov_b32 vcc_lo, 0xfc000000
    s_mov_b32 vcc_hi, 0xc0000000
    v_cndmask_b32_e64 v142, v111, 0, vcc
    v_cndmask_b32 v158, 0, v111, vcc
    s_mov_b32 vcc_lo, 0xf8000000
    s_mov_b32 vcc_hi, 0x80000000
    v_cndmask_b32_e64 v143, v111, 0, vcc
    v_cndmask_b32 v159, 0, v111, vcc
    ds_read_b64_tr_b16 v[44:45], v10 offset:6144
    ds_read_b64_tr_b16 v[46:47], v10 offset:6656
    s_waitcnt lgkmcnt(6)
    v_mfma_f32_32x32x16_bf16 v[16:31], v[32:35], v[192:195], v[16:31]
    ds_read_b64_tr_b16 v[32:33], v10 offset:8192
    ds_read_b64_tr_b16 v[34:35], v10 offset:8704
    s_waitcnt lgkmcnt(6)
    v_mfma_f32_32x32x16_bf16 v[16:31], v[36:39], v[196:199], v[16:31]
    v_mov_b32 v180, v14
    s_lshl_b32 s6, s67, 16
    v_lshl_add_u32 v182, v0, 4, s6
    s_lshl_b32 s6, s68, 13
    v_add_u32 v183, s6, v182
    v_and_b32 v4, 31, v1
    ds_read_b64_tr_b16 v[36:37], v10 offset:10240
    ds_read_b64_tr_b16 v[38:39], v10 offset:10752
    s_waitcnt lgkmcnt(6)
    v_mfma_f32_32x32x16_bf16 v[16:31], v[40:43], v[200:203], v[16:31]
    v_lshlrev_b32 v195, 7, v4
    ds_read_b64_tr_b16 v[40:41], v10 offset:12288
    ds_read_b64_tr_b16 v[42:43], v10 offset:12800
    s_waitcnt lgkmcnt(6)
    v_mfma_f32_32x32x16_bf16 v[16:31], v[44:47], v[204:207], v[16:31]
    ds_read_b64_tr_b16 v[44:45], v10 offset:14336
    ds_read_b64_tr_b16 v[46:47], v10 offset:14848
    s_waitcnt lgkmcnt(6)
    v_mfma_f32_32x32x16_bf16 v[16:31], v[32:35], v[208:211], v[16:31]
    ds_read_b64_tr_b16 v[32:33], v10 offset:16384
    ds_read_b64_tr_b16 v[34:35], v10 offset:16896
    s_waitcnt lgkmcnt(6)
    v_mfma_f32_32x32x16_bf16 v[16:31], v[36:39], v[212:215], v[16:31]
    ds_read_b64_tr_b16 v[36:37], v10 offset:18432
    ds_read_b64_tr_b16 v[38:39], v10 offset:18944
    s_waitcnt lgkmcnt(6)
    v_mfma_f32_32x32x16_bf16 v[16:31], v[40:43], v[216:219], v[16:31]
    ds_read_b64_tr_b16 v[40:41], v10 offset:20480
    ds_read_b64_tr_b16 v[42:43], v10 offset:20992
    s_waitcnt lgkmcnt(6)
    v_mfma_f32_32x32x16_bf16 v[16:31], v[44:47], v[220:223], v[16:31]
    ds_read_b64_tr_b16 v[44:45], v10 offset:22528
    ds_read_b64_tr_b16 v[46:47], v10 offset:23040
    s_waitcnt lgkmcnt(6)
    v_mfma_f32_32x32x16_bf16 v[16:31], v[32:35], v[224:227], v[16:31]
    ds_read_b64_tr_b16 v[32:33], v10 offset:24576
    ds_read_b64_tr_b16 v[34:35], v10 offset:25088
    s_waitcnt lgkmcnt(6)
    v_mfma_f32_32x32x16_bf16 v[16:31], v[36:39], v[228:231], v[16:31]
    ds_read_b64_tr_b16 v[36:37], v10 offset:26624
    ds_read_b64_tr_b16 v[38:39], v10 offset:27136
    s_waitcnt lgkmcnt(6)
    v_mfma_f32_32x32x16_bf16 v[16:31], v[40:43], v[232:235], v[16:31]
    s_add_u32 s71, s71, 65536
    s_cmp_lg_u32 s3, 0
    s_cbranch_scc1 L_pdone_fa
    s_lshl_b32 s6, s4, 13
    s_add_u32 s6, s6, 16908288
    s_mov_b32 s7, 0x20000
    s_add_u32 s76, s6, 4096
L_poll_fa:
    buffer_load_dword v2, v195, s[8:11], s76 offen sc1
    s_waitcnt vmcnt(0)
    v_cmp_ne_u32 vcc, s85, v2
    s_cbranch_vccz L_pdone_fa
    buffer_load_dword v2, v195, s[8:11], s76 offen sc1
    s_waitcnt vmcnt(0)
    v_cmp_ne_u32 vcc, s85, v2
    s_cbranch_vccz L_pdone_fa
    buffer_load_dword v2, v195, s[8:11], s76 offen sc1
    s_waitcnt vmcnt(0)
    v_cmp_ne_u32 vcc, s85, v2
    s_cbranch_vccz L_pdone_fa
    buffer_load_dword v2, v195, s[8:11], s76 offen sc1
    s_waitcnt vmcnt(0)
    v_cmp_ne_u32 vcc, s85, v2
    s_cbranch_vccz L_pdone_fa
    buffer_load_dword v2, v195, s[8:11], s6 offen sc1
    s_waitcnt vmcnt(0)
    v_cmp_ne_u32 vcc, s85, v2
    s_cbranch_vccz L_pdone_fa
    s_sub_u32 s7, s7, 1
    s_cbranch_scc0 L_poll_fa
L_pdone_fa:
    s_barrier
    s_add_u32 m0, s66, 0
    s_mov_b32 s6, 2097152
    buffer_load_dwordx4 v182, s[8:11], s6 offen sc1 lds
    buffer_load_dwordx4 v[84:87], v183, s[8:11], 0 offen sc1
    s_add_u32 m0, s66, 65536
    s_mov_b32 s6, 4194304
    buffer_load_dwordx4 v182, s[8:11], s6 offen sc1 lds
    ds_read_b64_tr_b16 v[40:41], v10 offset:28672
    ds_read_b64_tr_b16 v[42:43], v10 offset:29184
    s_waitcnt lgkmcnt(6)
    v_mfma_f32_32x32x16_bf16 v[16:31], v[44:47], v[236:239], v[16:31]
    ds_read_b64_tr_b16 v[44:45], v10 offset:30720
    ds_read_b64_tr_b16 v[46:47], v10 offset:31232
    s_waitcnt lgkmcnt(6)
    v_mfma_f32_32x32x16_bf16 v[16:31], v[32:35], v[240:243], v[16:31]
    s_waitcnt lgkmcnt(4)
    v_mfma_f32_32x32x16_bf16 v[16:31], v[36:39], v[244:247], v[16:31]
    v_mov_b32 v228, 0
    v_mov_b32 v229, 0
    v_mov_b32 v230, 0
    v_mov_b32 v231, 0
    s_waitcnt lgkmcnt(2)
    v_mfma_f32_32x32x16_bf16 v[16:31], v[40:43], v[248:251], v[16:31]
    v_mov_b32 v232, 0
    v_mov_b32 v233, 0
    v_mov_b32 v234, 0
    v_mov_b32 v235, 0
    s_waitcnt lgkmcnt(0)
    v_mfma_f32_32x32x16_bf16 v[16:31], v[44:47], v[252:255], v[16:31]
    v_mov_b32 v236, 0
    v_mov_b32 v237, 0
    v_mov_b32 v238, 0
    v_mov_b32 v239, 0
    v_mov_b32 v240, 0
    v_mov_b32 v241, 0
    v_mov_b32 v242, 0
    v_mov_b32 v243, 0
    s_mov_b32 s79, s70
    v_subrev_u32 v181, 65536, v102
    v_lshrrev_b32 v6, 3, v0
    v_and_b32 v7, 7, v0
    v_lshrrev_b32 v184, 2, v0
    v_and_b32 v184, 4, v184
    v_xor_b32 v184, v184, v7
    v_lshlrev_b32 v184, 4, v184
    v_lshl_add_u32 v184, v6, 10, v184
    s_and_b32 s6, s5, 7
    s_lshl_b32 s6, s6, 7
    v_add_u32 v184, s6, v184
    s_cmp_eq_u32 s68, 0
    s_cselect_b32 s74, s3, 8
    s_lshl_b32 s78, s68, 3
    s_add_u32 s78, s78, s3
    s_lshl_b32 s78, s78, 5
    s_add_u32 s78, s78, s67
    s_lshl_b32 s78, s78, 10
    s_add_u32 s78, s78, 12582912
    s_mov_b32 s64, 0xffff
    s_mov_b32 s65, 0xffff
    s_mov_b32 s48, s20
    s_mov_b32 s49, s21
    s_mov_b32 s50, 524288
    s_mov_b32 s51, 0x20000
    s_mov_b32 s52, s26
    s_mov_b32 s53, s27
    s_mov_b32 s54, 524288
    s_mov_b32 s55, 0x20000
    s_mov_b32 s56, s30
    s_mov_b32 s57, s31
    s_mov_b32 s58, 2097152
    s_mov_b32 s59, 0x20000
    s_waitcnt vmcnt(3)
    v_lshlrev_b32 v60, 16, v112
    v_lshlrev_b32 v61, 16, v116
    v_mul_f32 v62, v60, v61
    v_and_b32 v60, 0xffff0000, v112
    v_and_b32 v61, 0xffff0000, v116
    v_fmac_f32 v62, v60, v61
    v_lshlrev_b32 v60, 16, v113
    v_lshlrev_b32 v61, 16, v117
    v_fmac_f32 v62, v60, v61
    v_and_b32 v60, 0xffff0000, v113
    v_and_b32 v61, 0xffff0000, v117
    v_fmac_f32 v62, v60, v61
    v_lshlrev_b32 v60, 16, v114
    v_lshlrev_b32 v61, 16, v118
    v_fmac_f32 v62, v60, v61
    v_and_b32 v60, 0xffff0000, v114
    v_and_b32 v61, 0xffff0000, v118
    v_fmac_f32 v62, v60, v61
    v_lshlrev_b32 v60, 16, v115
    v_lshlrev_b32 v61, 16, v119
    v_fmac_f32 v62, v60, v61
    v_and_b32 v60, 0xffff0000, v115
    v_and_b32 v61, 0xffff0000, v119
    v_fmac_f32 v62, v60, v61
    s_nop 1
    v_add_f32_dpp v62, v62, v62 row_shr:1 row_mask:0xf bank_mask:0xf bound_ctrl:0
    s_nop 1
    v_add_f32_dpp v62, v62, v62 row_shr:2 row_mask:0xf bank_mask:0xf bound_ctrl:0
    s_nop 1
    v_add_f32_dpp v62, v62, v62 row_shr:4 row_mask:0xf bank_mask:0xf bound_ctrl:0
    s_nop 1
    v_add_f32_dpp v62, v62, v62 row_shr:8 row_mask:0xf bank_mask:0xf bound_ctrl:0
    s_nop 1
    v_add_f32_dpp v62, v62, v62 row_bcast:15 row_mask:0xa bank_mask:0xf
    s_nop 1
    v_add_f32_dpp v62, v62, v62 row_bcast:31 row_mask:0xc bank_mask:0xf
    v_cvt_pk_bf16_f32 v62, v62, v62
    v_lshlrev_b32 v62, 16, v62
    v_mul_f32 v62, 3216550459, v62
    v_exp_f32 v62, v62
    s_nop 0
    v_add_f32 v62, 1.0, v62
    v_rcp_f32 v62, v62
    s_nop 0
    v_cvt_pk_bf16_f32 v62, v62, v62
    v_lshlrev_b32 v62, 16, v62
    s_nop 0
    v_readlane_b32 s60, v62, 63
    v_pk_mul_f32 v[16:17], v[16:17], s[80:81]
    v_pk_mul_f32 v[18:19], v[18:19], s[80:81]
    v_pk_mul_f32 v[20:21], v[20:21], s[80:81]
    v_pk_mul_f32 v[22:23], v[22:23], s[80:81]
    v_cvt_pk_bf16_f32 v112, v16, v17
    v_cvt_pk_bf16_f32 v113, v18, v19
    v_cvt_pk_bf16_f32 v114, v20, v21
    v_cvt_pk_bf16_f32 v115, v22, v23
    v_pk_mul_f32 v[24:25], v[24:25], s[80:81]
    v_pk_mul_f32 v[26:27], v[26:27], s[80:81]
    v_pk_mul_f32 v[28:29], v[28:29], s[80:81]
    v_pk_mul_f32 v[30:31], v[30:31], s[80:81]
    v_cvt_pk_bf16_f32 v116, v24, v25
    v_cvt_pk_bf16_f32 v117, v26, v27
    v_cvt_pk_bf16_f32 v118, v28, v29
    v_cvt_pk_bf16_f32 v119, v30, v31
    s_waitcnt vmcnt(0) lgkmcnt(0)
    s_barrier
    ds_read_b128 v[80:83], v180 offset:0
    s_add_u32 m0, s66, 8192
    s_mov_b32 s6, 2105344
    buffer_load_dwordx4 v182, s[8:11], s6 offen sc1 lds
    s_add_u32 m0, s66, 73728
    s_mov_b32 s6, 4202496
    buffer_load_dwordx4 v182, s[8:11], s6 offen sc1 lds
    s_waitcnt lgkmcnt(0)
    v_mfma_f32_32x32x16_bf16 v[16:31], v[80:83], v[84:87], 0
    ds_read_b128 v[80:83], v180 offset:1024
    s_mov_b64 exec, s[64:65]
    ds_read_b128 v[88:91], v102 offset:0
    ds_read_b128 v[92:95], v102 offset:512
    s_mov_b64 exec, -1
    s_nop 6
    v_max3_f32 v103, v16, v17, v18
    v_max3_f32 v105, v19, v20, v21
    v_max3_f32 v103, v103, v22, v23
    v_max3_f32 v105, v105, v24, v25
    v_max3_f32 v103, v103, v26, v27
    v_max3_f32 v105, v105, v28, v29
    v_max3_f32 v103, v103, v30, v31
    v_max_f32 v103, v103, v105
    v_mov_b32 v105, v103
    s_nop 1
    v_permlane32_swap_b32 v103, v105
    v_max_f32 v103, v103, v105
    v_sub_f32 v106, 0, v103
    v_sub_f32 v107, 0, v103
    v_pk_add_f32 v[16:17], v[16:17], v[106:107]
    v_pk_add_f32 v[18:19], v[18:19], v[106:107]
    v_pk_add_f32 v[20:21], v[20:21], v[106:107]
    v_pk_add_f32 v[22:23], v[22:23], v[106:107]
    v_pk_add_f32 v[24:25], v[24:25], v[106:107]
    v_pk_add_f32 v[26:27], v[26:27], v[106:107]
    v_pk_add_f32 v[28:29], v[28:29], v[106:107]
    v_pk_add_f32 v[30:31], v[30:31], v[106:107]
    v_pk_mov_b32 v[48:49], v[106:107], v[106:107]
    v_pk_mov_b32 v[50:51], v[106:107], v[106:107]
    v_pk_mov_b32 v[52:53], v[106:107], v[106:107]
    v_pk_mov_b32 v[54:55], v[106:107], v[106:107]
    v_pk_mov_b32 v[56:57], v[106:107], v[106:107]
    v_pk_mov_b32 v[58:59], v[106:107], v[106:107]
    v_pk_mov_b32 v[60:61], v[106:107], v[106:107]
    v_pk_mov_b32 v[62:63], v[106:107], v[106:107]
    s_setprio 3
    v_exp_f32 v16, v16
    v_exp_f32 v17, v17
    v_exp_f32 v18, v18
    v_exp_f32 v19, v19
    s_waitcnt lgkmcnt(2)
    v_mfma_f32_32x32x16_bf16 v[32:47], v[80:83], v[84:87], v[48:63]
    ds_read_b128 v[80:83], v180 offset:2048
    v_exp_f32 v20, v20
    v_exp_f32 v21, v21
    v_exp_f32 v22, v22
    v_exp_f32 v23, v23
    v_exp_f32 v24, v24
    v_exp_f32 v25, v25
    s_waitcnt lgkmcnt(1)
    v_smfmac_f32_32x32x32_bf16 v[64:79], v[88:91], v[16:23], v100
    s_mov_b64 exec, s[64:65]
    ds_read_b128 v[88:91], v102 offset:1024
    ds_read_b128 v[96:99], v102 offset:1536
    s_mov_b64 exec, -1
    v_exp_f32 v26, v26
    v_exp_f32 v27, v27
    v_exp_f32 v28, v28
    s_add_u32 m0, s66, 16384
    s_mov_b32 s6, 2113536
    buffer_load_dwordx4 v182, s[8:11], s6 offen sc1 lds
    s_add_u32 m0, s66, 81920
    s_mov_b32 s6, 4210688
    buffer_load_dwordx4 v182, s[8:11], s6 offen sc1 lds
    v_exp_f32 v29, v29
    v_exp_f32 v30, v30
    v_exp_f32 v31, v31
    s_setprio 2
    v_exp_f32 v32, v32
    v_exp_f32 v33, v33
    v_smfmac_f32_32x32x32_bf16 v[64:79], v[92:95], v[24:31], v100
    v_exp_f32 v34, v34
    v_exp_f32 v35, v35
    s_waitcnt lgkmcnt(2)
    v_mfma_f32_32x32x16_bf16 v[16:31], v[80:83], v[84:87], v[48:63]
    ds_read_b128 v[80:83], v180 offset:3072
    v_exp_f32 v36, v36
    v_exp_f32 v37, v37
    v_exp_f32 v38, v38
    v_exp_f32 v39, v39
    v_exp_f32 v40, v40
    v_exp_f32 v41, v41
    s_waitcnt lgkmcnt(1)
    v_smfmac_f32_32x32x32_bf16 v[64:79], v[88:91], v[32:39], v100
    s_mov_b64 exec, s[64:65]
    ds_read_b128 v[88:91], v102 offset:2048
    ds_read_b128 v[92:95], v102 offset:2560
    s_mov_b64 exec, -1
    v_exp_f32 v42, v42
    v_exp_f32 v43, v43
    v_exp_f32 v44, v44
    s_add_u32 m0, s66, 24576
    s_mov_b32 s6, 2121728
    buffer_load_dwordx4 v182, s[8:11], s6 offen sc1 lds
    s_add_u32 m0, s66, 90112
    s_mov_b32 s6, 4218880
    buffer_load_dwordx4 v182, s[8:11], s6 offen sc1 lds
    v_exp_f32 v45, v45
    v_exp_f32 v46, v46
    v_exp_f32 v47, v47
    s_setprio 1
    v_exp_f32 v16, v16
    v_exp_f32 v17, v17
    v_smfmac_f32_32x32x32_bf16 v[64:79], v[96:99], v[40:47], v100
    v_exp_f32 v18, v18
    v_exp_f32 v19, v19
    s_waitcnt lgkmcnt(2)
    v_mfma_f32_32x32x16_bf16 v[32:47], v[80:83], v[84:87], v[48:63]
    ds_read_b128 v[80:83], v180 offset:4096
    v_exp_f32 v20, v20
    v_exp_f32 v21, v21
    v_exp_f32 v22, v22
    v_exp_f32 v23, v23
    v_exp_f32 v24, v24
    v_exp_f32 v25, v25
    s_waitcnt lgkmcnt(1)
    v_smfmac_f32_32x32x32_bf16 v[64:79], v[88:91], v[16:23], v100
    s_mov_b64 exec, s[64:65]
    ds_read_b128 v[88:91], v102 offset:3072
    ds_read_b128 v[96:99], v102 offset:3584
    s_mov_b64 exec, -1
    v_exp_f32 v26, v26
    v_exp_f32 v27, v27
    v_exp_f32 v28, v28
    buffer_store_dwordx4 v[112:115], v12, s[8:11], s84 offen sc1
    v_exp_f32 v29, v29
    v_exp_f32 v30, v30
    v_exp_f32 v31, v31
    s_setprio 0
    v_exp_f32 v32, v32
    v_exp_f32 v33, v33
    v_smfmac_f32_32x32x32_bf16 v[64:79], v[92:95], v[24:31], v100
    v_exp_f32 v34, v34
    v_exp_f32 v35, v35
    s_waitcnt lgkmcnt(2)
    v_mfma_f32_32x32x16_bf16 v[16:31], v[80:83], v[84:87], v[48:63]
    ds_read_b128 v[80:83], v180 offset:5120
    v_exp_f32 v36, v36
    v_exp_f32 v37, v37
    v_exp_f32 v38, v38
    v_exp_f32 v39, v39
    v_exp_f32 v40, v40
    v_exp_f32 v41, v41
    s_waitcnt lgkmcnt(1)
    v_smfmac_f32_32x32x32_bf16 v[64:79], v[88:91], v[32:39], v100
    s_mov_b64 exec, s[64:65]
    ds_read_b128 v[88:91], v102 offset:4096
    ds_read_b128 v[92:95], v102 offset:4608
    s_mov_b64 exec, -1
    v_exp_f32 v42, v42
    v_exp_f32 v43, v43
    v_exp_f32 v44, v44
    buffer_store_dwordx4 v[120:123], v13, s[8:11], s83 offen sc1
    v_exp_f32 v45, v45
    v_exp_f32 v46, v46
    v_exp_f32 v47, v47
    s_setprio 3
    v_exp_f32 v16, v16
    v_exp_f32 v17, v17
    v_smfmac_f32_32x32x32_bf16 v[64:79], v[96:99], v[40:47], v100
    v_exp_f32 v18, v18
    v_exp_f32 v19, v19
    s_waitcnt lgkmcnt(2)
    v_mfma_f32_32x32x16_bf16 v[32:47], v[80:83], v[84:87], v[48:63]
    ds_read_b128 v[80:83], v180 offset:6144
    v_exp_f32 v20, v20
    v_exp_f32 v21, v21
    v_exp_f32 v22, v22
    v_exp_f32 v23, v23
    v_exp_f32 v24, v24
    v_exp_f32 v25, v25
    s_waitcnt lgkmcnt(1)
    v_smfmac_f32_32x32x32_bf16 v[64:79], v[88:91], v[16:23], v100
    s_mov_b64 exec, s[64:65]
    ds_read_b128 v[88:91], v102 offset:5120
    ds_read_b128 v[96:99], v102 offset:5632
    s_mov_b64 exec, -1
    v_exp_f32 v26, v26
    v_exp_f32 v27, v27
    v_exp_f32 v28, v28
    v_exp_f32 v29, v29
    v_exp_f32 v30, v30
    v_exp_f32 v31, v31
    s_setprio 2
    v_exp_f32 v32, v32
    v_exp_f32 v33, v33
    v_smfmac_f32_32x32x32_bf16 v[64:79], v[92:95], v[24:31], v100
    v_exp_f32 v34, v34
    v_exp_f32 v35, v35
    s_waitcnt lgkmcnt(2)
    v_mfma_f32_32x32x16_bf16 v[16:31], v[80:83], v[84:87], v[48:63]
    ds_read_b128 v[80:83], v180 offset:7168
    v_exp_f32 v36, v36
    v_exp_f32 v37, v37
    v_exp_f32 v38, v38
    v_exp_f32 v39, v39
    v_exp_f32 v40, v40
    v_exp_f32 v41, v41
    s_waitcnt lgkmcnt(1)
    v_smfmac_f32_32x32x32_bf16 v[64:79], v[88:91], v[32:39], v100
    s_mov_b64 exec, s[64:65]
    ds_read_b128 v[88:91], v102 offset:6144
    ds_read_b128 v[92:95], v102 offset:6656
    s_mov_b64 exec, -1
    v_exp_f32 v42, v42
    v_exp_f32 v43, v43
    v_exp_f32 v44, v44
    s_add_u32 s7, s84, 65536
    buffer_store_dwordx4 v[116:119], v12, s[8:11], s7 offen sc1
    v_exp_f32 v45, v45
    v_exp_f32 v46, v46
    v_exp_f32 v47, v47
    s_waitcnt vmcnt(7)
    s_barrier
    s_setprio 1
    v_exp_f32 v16, v16
    v_exp_f32 v17, v17
    v_smfmac_f32_32x32x32_bf16 v[64:79], v[96:99], v[40:47], v100
    v_exp_f32 v18, v18
    v_exp_f32 v19, v19
    s_waitcnt lgkmcnt(2)
    v_mfma_f32_32x32x16_bf16 v[32:47], v[80:83], v[84:87], v[48:63]
    ds_read_b128 v[80:83], v180 offset:8192
    v_exp_f32 v20, v20
    v_exp_f32 v21, v21
    v_exp_f32 v22, v22
    v_exp_f32 v23, v23
    v_exp_f32 v24, v24
    v_exp_f32 v25, v25
    s_waitcnt lgkmcnt(1)
    v_smfmac_f32_32x32x32_bf16 v[64:79], v[88:91], v[16:23], v100
    s_mov_b64 exec, s[64:65]
    ds_read_b128 v[88:91], v102 offset:7168
    ds_read_b128 v[96:99], v102 offset:7680
    s_mov_b64 exec, -1
    v_exp_f32 v26, v26
    v_exp_f32 v27, v27
    v_exp_f32 v28, v28
    v_exp_f32 v29, v29
    v_exp_f32 v30, v30
    v_exp_f32 v31, v31
    s_setprio 0
    v_exp_f32 v32, v32
    v_exp_f32 v33, v33
    v_smfmac_f32_32x32x32_bf16 v[64:79], v[92:95], v[24:31], v100
    v_exp_f32 v34, v34
    v_exp_f32 v35, v35
    s_waitcnt lgkmcnt(2)
    v_mfma_f32_32x32x16_bf16 v[16:31], v[80:83], v[84:87], v[48:63]
    ds_read_b128 v[80:83], v180 offset:9216
    v_exp_f32 v36, v36
    v_exp_f32 v37, v37
    v_exp_f32 v38, v38
    v_exp_f32 v39, v39
    v_exp_f32 v40, v40
    v_exp_f32 v41, v41
    s_waitcnt lgkmcnt(1)
    v_smfmac_f32_32x32x32_bf16 v[64:79], v[88:91], v[32:39], v100
    s_mov_b64 exec, s[64:65]
    ds_read_b128 v[88:91], v102 offset:8192
    ds_read_b128 v[92:95], v102 offset:8704
    s_mov_b64 exec, -1
    v_exp_f32 v42, v42
    v_exp_f32 v43, v43
    v_exp_f32 v44, v44
    buffer_store_dwordx4 v[124:127], v13, s[8:11], s83 offen offset:512 sc1
    v_exp_f32 v45, v45
    v_exp_f32 v46, v46
    v_exp_f32 v47, v47
    s_setprio 3
    v_exp_f32 v16, v16
    v_exp_f32 v17, v17
    v_smfmac_f32_32x32x32_bf16 v[64:79], v[96:99], v[40:47], v100
    v_exp_f32 v18, v18
    v_exp_f32 v19, v19
    s_waitcnt lgkmcnt(2)
    v_mfma_f32_32x32x16_bf16 v[32:47], v[80:83], v[84:87], v[48:63]
    ds_read_b128 v[80:83], v180 offset:10240
    v_exp_f32 v20, v20
    v_exp_f32 v21, v21
    v_exp_f32 v22, v22
    v_exp_f32 v23, v23
    v_exp_f32 v24, v24
    v_exp_f32 v25, v25
    s_waitcnt lgkmcnt(1)
    v_smfmac_f32_32x32x32_bf16 v[64:79], v[88:91], v[16:23], v100
    s_mov_b64 exec, s[64:65]
    ds_read_b128 v[88:91], v102 offset:9216
    ds_read_b128 v[96:99], v102 offset:9728
    s_mov_b64 exec, -1
    v_exp_f32 v26, v26
    v_exp_f32 v27, v27
    v_exp_f32 v28, v28
    s_add_u32 m0, s66, 32768
    s_mov_b32 s6, 2129920
    buffer_load_dwordx4 v182, s[8:11], s6 offen sc1 lds
    v_exp_f32 v29, v29
    v_exp_f32 v30, v30
    v_exp_f32 v31, v31
    s_setprio 2
    v_exp_f32 v32, v32
    v_exp_f32 v33, v33
    v_smfmac_f32_32x32x32_bf16 v[64:79], v[92:95], v[24:31], v100
    v_exp_f32 v34, v34
    v_exp_f32 v35, v35
    s_waitcnt lgkmcnt(2)
    v_mfma_f32_32x32x16_bf16 v[16:31], v[80:83], v[84:87], v[48:63]
    ds_read_b128 v[80:83], v180 offset:11264
    v_exp_f32 v36, v36
    v_exp_f32 v37, v37
    v_exp_f32 v38, v38
    v_exp_f32 v39, v39
    v_exp_f32 v40, v40
    v_exp_f32 v41, v41
    s_waitcnt lgkmcnt(1)
    v_smfmac_f32_32x32x32_bf16 v[64:79], v[88:91], v[32:39], v100
    s_mov_b64 exec, s[64:65]
    ds_read_b128 v[88:91], v102 offset:10240
    ds_read_b128 v[92:95], v102 offset:10752
    s_mov_b64 exec, -1
    v_exp_f32 v42, v42
    v_exp_f32 v43, v43
    v_exp_f32 v44, v44
    s_add_u32 m0, s66, 98304
    s_mov_b32 s6, 4227072
    buffer_load_dwordx4 v182, s[8:11], s6 offen sc1 lds
    v_exp_f32 v45, v45
    v_exp_f32 v46, v46
    v_exp_f32 v47, v47
    s_setprio 1
    v_exp_f32 v16, v16
    v_exp_f32 v17, v17
    v_smfmac_f32_32x32x32_bf16 v[64:79], v[96:99], v[40:47], v100
    v_exp_f32 v18, v18
    v_exp_f32 v19, v19
    s_waitcnt lgkmcnt(2)
    v_mfma_f32_32x32x16_bf16 v[32:47], v[80:83], v[84:87], v[48:63]
    ds_read_b128 v[80:83], v180 offset:12288
    v_exp_f32 v20, v20
    v_exp_f32 v21, v21
    v_exp_f32 v22, v22
    v_exp_f32 v23, v23
    v_exp_f32 v24, v24
    v_exp_f32 v25, v25
    s_waitcnt lgkmcnt(1)
    v_smfmac_f32_32x32x32_bf16 v[64:79], v[88:91], v[16:23], v100
    s_mov_b64 exec, s[64:65]
    ds_read_b128 v[88:91], v102 offset:11264
    ds_read_b128 v[96:99], v102 offset:11776
    s_mov_b64 exec, -1
    v_exp_f32 v26, v26
    v_exp_f32 v27, v27
    v_exp_f32 v28, v28
    s_add_u32 m0, s66, 40960
    s_mov_b32 s6, 2138112
    buffer_load_dwordx4 v182, s[8:11], s6 offen sc1 lds
    v_exp_f32 v29, v29
    v_exp_f32 v30, v30
    v_exp_f32 v31, v31
    s_setprio 0
    v_exp_f32 v32, v32
    v_exp_f32 v33, v33
    v_smfmac_f32_32x32x32_bf16 v[64:79], v[92:95], v[24:31], v100
    v_exp_f32 v34, v34
    v_exp_f32 v35, v35
    s_waitcnt lgkmcnt(2)
    v_mfma_f32_32x32x16_bf16 v[16:31], v[80:83], v[84:87], v[48:63]
    ds_read_b128 v[80:83], v180 offset:13312
    v_exp_f32 v36, v36
    v_exp_f32 v37, v37
    v_exp_f32 v38, v38
    v_exp_f32 v39, v39
    v_exp_f32 v40, v40
    v_exp_f32 v41, v41
    s_waitcnt lgkmcnt(1)
    v_smfmac_f32_32x32x32_bf16 v[64:79], v[88:91], v[32:39], v100
    s_mov_b64 exec, s[64:65]
    ds_read_b128 v[88:91], v102 offset:12288
    ds_read_b128 v[92:95], v102 offset:12800
    s_mov_b64 exec, -1
    v_exp_f32 v42, v42
    v_exp_f32 v43, v43
    v_exp_f32 v44, v44
    s_add_u32 m0, s66, 106496
    s_mov_b32 s6, 4235264
    buffer_load_dwordx4 v182, s[8:11], s6 offen sc1 lds
    v_exp_f32 v45, v45
    v_exp_f32 v46, v46
    v_exp_f32 v47, v47
    s_setprio 3
    v_exp_f32 v16, v16
    v_exp_f32 v17, v17
    v_smfmac_f32_32x32x32_bf16 v[64:79], v[96:99], v[40:47], v100
    v_exp_f32 v18, v18
    v_exp_f32 v19, v19
    s_waitcnt lgkmcnt(2)
    v_mfma_f32_32x32x16_bf16 v[32:47], v[80:83], v[84:87], v[48:63]
    ds_read_b128 v[80:83], v180 offset:14336
    v_exp_f32 v20, v20
    v_exp_f32 v21, v21
    v_exp_f32 v22, v22
    v_exp_f32 v23, v23
    v_exp_f32 v24, v24
    v_exp_f32 v25, v25
    s_waitcnt lgkmcnt(1)
    v_smfmac_f32_32x32x32_bf16 v[64:79], v[88:91], v[16:23], v100
    s_mov_b64 exec, s[64:65]
    ds_read_b128 v[88:91], v102 offset:13312
    ds_read_b128 v[96:99], v102 offset:13824
    s_mov_b64 exec, -1
    v_exp_f32 v26, v26
    v_exp_f32 v27, v27
    v_exp_f32 v28, v28
    s_add_u32 m0, s66, 49152
    s_mov_b32 s6, 2146304
    buffer_load_dwordx4 v182, s[8:11], s6 offen sc1 lds
    v_exp_f32 v29, v29
    v_exp_f32 v30, v30
    v_exp_f32 v31, v31
    s_setprio 2
    v_exp_f32 v32, v32
    v_exp_f32 v33, v33
    v_smfmac_f32_32x32x32_bf16 v[64:79], v[92:95], v[24:31], v100
    v_exp_f32 v34, v34
    v_exp_f32 v35, v35
    s_waitcnt lgkmcnt(2)
    v_mfma_f32_32x32x16_bf16 v[16:31], v[80:83], v[84:87], v[48:63]
    ds_read_b128 v[80:83], v180 offset:15360
    v_exp_f32 v36, v36
    v_exp_f32 v37, v37
    v_exp_f32 v38, v38
    v_exp_f32 v39, v39
    v_exp_f32 v40, v40
    v_exp_f32 v41, v41
    s_waitcnt lgkmcnt(1)
    v_smfmac_f32_32x32x32_bf16 v[64:79], v[88:91], v[32:39], v100
    s_mov_b64 exec, s[64:65]
    ds_read_b128 v[88:91], v102 offset:14336
    ds_read_b128 v[92:95], v102 offset:14848
    s_mov_b64 exec, -1
    v_exp_f32 v42, v42
    v_exp_f32 v43, v43
    v_exp_f32 v44, v44
    s_add_u32 m0, s66, 114688
    s_mov_b32 s6, 4243456
    buffer_load_dwordx4 v182, s[8:11], s6 offen sc1 lds
    v_exp_f32 v45, v45
    v_exp_f32 v46, v46
    v_exp_f32 v47, v47
    s_waitcnt vmcnt(6)
    s_barrier
    s_cmp_lg_u32 s3, 0
    s_cbranch_scc1 L_nofb
    v_mov_b32 v104, s85
    v_mov_b32 v105, s60
    v_mov_b32 v106, s85
    v_mov_b32 v107, s60
    s_mov_b64 exec, 0xff
    buffer_store_dwordx4 v[104:107], v180, s[8:11], s71 offen sc1
    s_mov_b64 exec, -1
L_nofb:
    s_setprio 1
    v_exp_f32 v16, v16
    v_exp_f32 v17, v17
    v_smfmac_f32_32x32x32_bf16 v[64:79], v[96:99], v[40:47], v100
    v_exp_f32 v18, v18
    v_exp_f32 v19, v19
    s_waitcnt lgkmcnt(2)
    v_mfma_f32_32x32x16_bf16 v[32:47], v[80:83], v[84:87], v[48:63]
    ds_read_b128 v[80:83], v180 offset:16384
    v_exp_f32 v20, v20
    v_exp_f32 v21, v21
    v_exp_f32 v22, v22
    v_exp_f32 v23, v23
    v_exp_f32 v24, v24
    v_exp_f32 v25, v25
    s_waitcnt lgkmcnt(1)
    v_smfmac_f32_32x32x32_bf16 v[64:79], v[88:91], v[16:23], v100
    s_mov_b64 exec, s[64:65]
    ds_read_b128 v[88:91], v102 offset:15360
    ds_read_b128 v[96:99], v102 offset:15872
    s_mov_b64 exec, -1
    v_exp_f32 v26, v26
    v_exp_f32 v27, v27
    v_exp_f32 v28, v28
    s_add_u32 m0, s66, 57344
    s_mov_b32 s6, 2154496
    buffer_load_dwordx4 v182, s[8:11], s6 offen sc1 lds
    v_exp_f32 v29, v29
    v_exp_f32 v30, v30
    v_exp_f32 v31, v31
    s_setprio 0
    v_exp_f32 v32, v32
    v_exp_f32 v33, v33
    v_smfmac_f32_32x32x32_bf16 v[64:79], v[92:95], v[24:31], v100
    v_exp_f32 v34, v34
    v_exp_f32 v35, v35
    s_waitcnt lgkmcnt(2)
    v_mfma_f32_32x32x16_bf16 v[16:31], v[80:83], v[84:87], v[48:63]
    ds_read_b128 v[80:83], v180 offset:17408
    v_exp_f32 v36, v36
    v_exp_f32 v37, v37
    v_exp_f32 v38, v38
    v_exp_f32 v39, v39
    v_exp_f32 v40, v40
    v_exp_f32 v41, v41
    s_waitcnt lgkmcnt(1)
    v_smfmac_f32_32x32x32_bf16 v[64:79], v[88:91], v[32:39], v100
    s_mov_b64 exec, s[64:65]
    ds_read_b128 v[88:91], v102 offset:16384
    ds_read_b128 v[92:95], v102 offset:16896
    s_mov_b64 exec, -1
    v_exp_f32 v42, v42
    v_exp_f32 v43, v43
    v_exp_f32 v44, v44
    s_add_u32 m0, s66, 122880
    s_mov_b32 s6, 4251648
    buffer_load_dwordx4 v182, s[8:11], s6 offen sc1 lds
    v_exp_f32 v45, v45
    v_exp_f32 v46, v46
    v_exp_f32 v47, v47
    s_setprio 3
    v_exp_f32 v16, v16
    v_exp_f32 v17, v17
    v_smfmac_f32_32x32x32_bf16 v[64:79], v[96:99], v[40:47], v100
    v_exp_f32 v18, v18
    v_exp_f32 v19, v19
    s_waitcnt lgkmcnt(2)
    v_mfma_f32_32x32x16_bf16 v[32:47], v[80:83], v[84:87], v[48:63]
    ds_read_b128 v[80:83], v180 offset:18432
    v_exp_f32 v20, v20
    v_exp_f32 v21, v21
    v_exp_f32 v22, v22
    v_exp_f32 v23, v23
    v_exp_f32 v24, v24
    v_exp_f32 v25, v25
    s_waitcnt lgkmcnt(1)
    v_smfmac_f32_32x32x32_bf16 v[64:79], v[88:91], v[16:23], v100
    s_mov_b64 exec, s[64:65]
    ds_read_b128 v[88:91], v102 offset:17408
    ds_read_b128 v[96:99], v102 offset:17920
    s_mov_b64 exec, -1
    v_exp_f32 v26, v26
    v_exp_f32 v27, v27
    v_exp_f32 v28, v28
    s_sub_u32 s6, s78, 12582912
    s_lshr_b32 s6, s6, 3
    s_add_u32 s6, s6, 17301504
    v_mov_b32 v104, s85
    v_mov_b32 v105, s60
    v_mov_b32 v106, s85
    v_mov_b32 v107, s60
    s_mov_b64 exec, 0xff
    buffer_store_dwordx4 v[104:107], v180, s[8:11], s6 offen sc1
    s_mov_b64 exec, -1
    v_exp_f32 v29, v29
    v_exp_f32 v30, v30
    v_exp_f32 v31, v31
    s_setprio 2
    v_exp_f32 v32, v32
    v_exp_f32 v33, v33
    v_smfmac_f32_32x32x32_bf16 v[64:79], v[92:95], v[24:31], v100
    v_exp_f32 v34, v34
    v_exp_f32 v35, v35
    s_waitcnt lgkmcnt(2)
    v_mfma_f32_32x32x16_bf16 v[16:31], v[80:83], v[84:87], v[48:63]
    ds_read_b128 v[80:83], v180 offset:19456
    v_exp_f32 v36, v36
    v_exp_f32 v37, v37
    v_exp_f32 v38, v38
    v_exp_f32 v39, v39
    v_exp_f32 v40, v40
    v_exp_f32 v41, v41
    s_waitcnt lgkmcnt(1)
    v_smfmac_f32_32x32x32_bf16 v[64:79], v[88:91], v[32:39], v100
    s_mov_b64 exec, s[64:65]
    ds_read_b128 v[88:91], v102 offset:18432
    ds_read_b128 v[92:95], v102 offset:18944
    s_mov_b64 exec, -1
    v_exp_f32 v42, v42
    v_exp_f32 v43, v43
    v_exp_f32 v44, v44
    v_exp_f32 v45, v45
    v_exp_f32 v46, v46
    v_exp_f32 v47, v47
    s_setprio 1
    v_exp_f32 v16, v16
    v_exp_f32 v17, v17
    v_smfmac_f32_32x32x32_bf16 v[64:79], v[96:99], v[40:47], v100
    v_exp_f32 v18, v18
    v_exp_f32 v19, v19
    s_waitcnt lgkmcnt(2)
    v_mfma_f32_32x32x16_bf16 v[32:47], v[80:83], v[84:87], v[48:63]
    ds_read_b128 v[80:83], v180 offset:20480
    v_exp_f32 v20, v20
    v_exp_f32 v21, v21
    v_exp_f32 v22, v22
    v_exp_f32 v23, v23
    v_exp_f32 v24, v24
    v_exp_f32 v25, v25
    s_waitcnt lgkmcnt(1)
    v_smfmac_f32_32x32x32_bf16 v[64:79], v[88:91], v[16:23], v100
    s_mov_b64 exec, s[64:65]
    ds_read_b128 v[88:91], v102 offset:19456
    ds_read_b128 v[96:99], v102 offset:19968
    s_mov_b64 exec, -1
    v_exp_f32 v26, v26
    v_exp_f32 v27, v27
    v_exp_f32 v28, v28
    v_exp_f32 v29, v29
    v_exp_f32 v30, v30
    v_exp_f32 v31, v31
    s_setprio 0
    v_exp_f32 v32, v32
    v_exp_f32 v33, v33
    v_smfmac_f32_32x32x32_bf16 v[64:79], v[92:95], v[24:31], v100
    v_exp_f32 v34, v34
    v_exp_f32 v35, v35
    s_waitcnt lgkmcnt(2)
    v_mfma_f32_32x32x16_bf16 v[16:31], v[80:83], v[84:87], v[48:63]
    ds_read_b128 v[80:83], v180 offset:21504
    v_exp_f32 v36, v36
    v_exp_f32 v37, v37
    v_exp_f32 v38, v38
    v_exp_f32 v39, v39
    v_exp_f32 v40, v40
    v_exp_f32 v41, v41
    s_waitcnt lgkmcnt(1)
    v_smfmac_f32_32x32x32_bf16 v[64:79], v[88:91], v[32:39], v100
    s_mov_b64 exec, s[64:65]
    ds_read_b128 v[88:91], v102 offset:20480
    ds_read_b128 v[92:95], v102 offset:20992
    s_mov_b64 exec, -1
    v_exp_f32 v42, v42
    v_exp_f32 v43, v43
    v_exp_f32 v44, v44
    s_lshl_b32 s6, s4, 13
    s_add_u32 s6, s6, 16973824
    buffer_load_dword v8, v195, s[8:11], s6 offen sc1
    v_exp_f32 v45, v45
    v_exp_f32 v46, v46
    v_exp_f32 v47, v47
    s_setprio 3
    v_exp_f32 v16, v16
    v_exp_f32 v17, v17
    v_smfmac_f32_32x32x32_bf16 v[64:79], v[96:99], v[40:47], v100
    v_exp_f32 v18, v18
    v_exp_f32 v19, v19
    s_waitcnt lgkmcnt(2)
    v_mfma_f32_32x32x16_bf16 v[32:47], v[80:83], v[84:87], v[48:63]
    ds_read_b128 v[80:83], v180 offset:22528
    v_exp_f32 v20, v20
    v_exp_f32 v21, v21
    v_exp_f32 v22, v22
    v_exp_f32 v23, v23
    v_exp_f32 v24, v24
    v_exp_f32 v25, v25
    s_waitcnt lgkmcnt(1)
    v_smfmac_f32_32x32x32_bf16 v[64:79], v[88:91], v[16:23], v100
    s_mov_b64 exec, s[64:65]
    ds_read_b128 v[88:91], v102 offset:21504
    ds_read_b128 v[96:99], v102 offset:22016
    s_mov_b64 exec, -1
    v_exp_f32 v26, v26
    v_exp_f32 v27, v27
    v_exp_f32 v28, v28
    v_exp_f32 v29, v29
    v_exp_f32 v30, v30
    v_exp_f32 v31, v31
    s_setprio 2
    v_exp_f32 v32, v32
    v_exp_f32 v33, v33
    v_smfmac_f32_32x32x32_bf16 v[64:79], v[92:95], v[24:31], v100
    v_exp_f32 v34, v34
    v_exp_f32 v35, v35
    s_waitcnt lgkmcnt(2)
    v_mfma_f32_32x32x16_bf16 v[16:31], v[80:83], v[84:87], v[48:63]
    ds_read_b128 v[80:83], v180 offset:23552
    v_exp_f32 v36, v36
    v_exp_f32 v37, v37
    v_exp_f32 v38, v38
    v_exp_f32 v39, v39
    v_exp_f32 v40, v40
    v_exp_f32 v41, v41
    s_waitcnt lgkmcnt(1)
    v_smfmac_f32_32x32x32_bf16 v[64:79], v[88:91], v[32:39], v100
    s_mov_b64 exec, s[64:65]
    ds_read_b128 v[88:91], v102 offset:22528
    ds_read_b128 v[92:95], v102 offset:23040
    s_mov_b64 exec, -1
    v_exp_f32 v42, v42
    v_exp_f32 v43, v43
    v_exp_f32 v44, v44
    v_exp_f32 v45, v45
    v_exp_f32 v46, v46
    v_exp_f32 v47, v47
    s_setprio 1
    v_exp_f32 v16, v16
    v_exp_f32 v17, v17
    v_smfmac_f32_32x32x32_bf16 v[64:79], v[96:99], v[40:47], v100
    v_exp_f32 v18, v18
    v_exp_f32 v19, v19
    s_waitcnt lgkmcnt(2)
    v_mfma_f32_32x32x16_bf16 v[32:47], v[80:83], v[84:87], v[48:63]
    ds_read_b128 v[80:83], v180 offset:24576
    v_exp_f32 v20, v20
    v_exp_f32 v21, v21
    v_exp_f32 v22, v22
    v_exp_f32 v23, v23
    v_exp_f32 v24, v24
    v_exp_f32 v25, v25
    s_waitcnt lgkmcnt(1)
    v_smfmac_f32_32x32x32_bf16 v[64:79], v[88:91], v[16:23], v100
    s_mov_b64 exec, s[64:65]
    ds_read_b128 v[88:91], v102 offset:23552
    ds_read_b128 v[96:99], v102 offset:24064
    s_mov_b64 exec, -1
    v_exp_f32 v26, v26
    v_exp_f32 v27, v27
    v_exp_f32 v28, v28
    s_waitcnt vmcnt(0)
    v_cmp_ne_u32 vcc, s85, v8
    s_lshl_b32 s72, s68, 13
    s_cbranch_vccnz L_fb_spin
L_fb_go:
    s_add_u32 s6, s72, 8388608
    s_add_u32 m0, s66, 139264
    s_nop 0
    buffer_load_dwordx4 v182, s[8:11], s6 offen sc1 lds
    v_exp_f32 v29, v29
    v_exp_f32 v30, v30
    v_exp_f32 v31, v31
    s_setprio 0
    v_exp_f32 v32, v32
    v_exp_f32 v33, v33
    v_smfmac_f32_32x32x32_bf16 v[64:79], v[92:95], v[24:31], v100
    v_exp_f32 v34, v34
    v_exp_f32 v35, v35
    s_waitcnt lgkmcnt(2)
    v_mfma_f32_32x32x16_bf16 v[16:31], v[80:83], v[84:87], v[48:63]
    ds_read_b128 v[80:83], v180 offset:25600
    v_exp_f32 v36, v36
    v_exp_f32 v37, v37
    v_exp_f32 v38, v38
    v_exp_f32 v39, v39
    v_exp_f32 v40, v40
    v_exp_f32 v41, v41
    s_waitcnt lgkmcnt(1)
    v_smfmac_f32_32x32x32_bf16 v[64:79], v[88:91], v[32:39], v100
    s_mov_b64 exec, s[64:65]
    ds_read_b128 v[88:91], v102 offset:24576
    ds_read_b128 v[92:95], v102 offset:25088
    s_mov_b64 exec, -1
    v_exp_f32 v42, v42
    v_exp_f32 v43, v43
    v_exp_f32 v44, v44
    s_add_u32 s6, s72, 10485760
    s_add_u32 m0, s66, 155648
    s_nop 0
    buffer_load_dwordx4 v182, s[8:11], s6 offen sc1 lds
    v_exp_f32 v45, v45
    v_exp_f32 v46, v46
    v_exp_f32 v47, v47
    s_setprio 3
    v_exp_f32 v16, v16
    v_exp_f32 v17, v17
    v_smfmac_f32_32x32x32_bf16 v[64:79], v[96:99], v[40:47], v100
    v_exp_f32 v18, v18
    v_exp_f32 v19, v19
    s_waitcnt lgkmcnt(2)
    v_mfma_f32_32x32x16_bf16 v[32:47], v[80:83], v[84:87], v[48:63]
    ds_read_b128 v[80:83], v180 offset:26624
    v_exp_f32 v20, v20
    v_exp_f32 v21, v21
    v_exp_f32 v22, v22
    v_exp_f32 v23, v23
    v_exp_f32 v24, v24
    v_exp_f32 v25, v25
    s_waitcnt lgkmcnt(1)
    v_smfmac_f32_32x32x32_bf16 v[64:79], v[88:91], v[16:23], v100
    s_mov_b64 exec, s[64:65]
    ds_read_b128 v[88:91], v102 offset:25600
    ds_read_b128 v[96:99], v102 offset:26112
    s_mov_b64 exec, -1
    v_exp_f32 v26, v26
    v_exp_f32 v27, v27
    v_exp_f32 v28, v28
    s_add_u32 s6, s72, 8380416
    s_cmp_eq_u32 s68, 0
    s_cselect_b32 s6, 0x80000000, s6
    s_add_u32 m0, s66, 131072
    s_nop 0
    buffer_load_dwordx4 v182, s[8:11], s6 offen sc1 lds
    v_exp_f32 v29, v29
    v_exp_f32 v30, v30
    v_exp_f32 v31, v31
    s_setprio 2
    v_exp_f32 v32, v32
    v_exp_f32 v33, v33
    v_smfmac_f32_32x32x32_bf16 v[64:79], v[92:95], v[24:31], v100
    v_exp_f32 v34, v34
    v_exp_f32 v35, v35
    s_waitcnt lgkmcnt(2)
    v_mfma_f32_32x32x16_bf16 v[16:31], v[80:83], v[84:87], v[48:63]
    ds_read_b128 v[80:83], v180 offset:27648
    v_exp_f32 v36, v36
    v_exp_f32 v37, v37
    v_exp_f32 v38, v38
    v_exp_f32 v39, v39
    v_exp_f32 v40, v40
    v_exp_f32 v41, v41
    s_waitcnt lgkmcnt(1)
    v_smfmac_f32_32x32x32_bf16 v[64:79], v[88:91], v[32:39], v100
    s_mov_b64 exec, s[64:65]
    ds_read_b128 v[88:91], v102 offset:26624
    ds_read_b128 v[92:95], v102 offset:27136
    s_mov_b64 exec, -1
    v_exp_f32 v42, v42
    v_exp_f32 v43, v43
    v_exp_f32 v44, v44
    s_add_u32 s6, s72, 10477568
    s_cmp_eq_u32 s68, 0
    s_cselect_b32 s6, 0x80000000, s6
    s_add_u32 m0, s66, 147456
    s_nop 0
    buffer_load_dwordx4 v182, s[8:11], s6 offen sc1 lds
    v_exp_f32 v45, v45
    v_exp_f32 v46, v46
    v_exp_f32 v47, v47
    s_setprio 1
    v_exp_f32 v16, v16
    v_exp_f32 v17, v17
    v_smfmac_f32_32x32x32_bf16 v[64:79], v[96:99], v[40:47], v100
    v_exp_f32 v18, v18
    v_exp_f32 v19, v19
    s_waitcnt lgkmcnt(2)
    v_mfma_f32_32x32x16_bf16 v[32:47], v[80:83], v[84:87], v[48:63]
    ds_read_b128 v[80:83], v180 offset:28672
    v_exp_f32 v20, v20
    v_exp_f32 v21, v21
    v_exp_f32 v22, v22
    v_exp_f32 v23, v23
    v_exp_f32 v24, v24
    v_exp_f32 v25, v25
    s_waitcnt lgkmcnt(1)
    v_smfmac_f32_32x32x32_bf16 v[64:79], v[88:91], v[16:23], v100
    s_mov_b64 exec, s[64:65]
    ds_read_b128 v[88:91], v102 offset:27648
    ds_read_b128 v[96:99], v102 offset:28160
    s_mov_b64 exec, -1
    v_exp_f32 v26, v26
    v_exp_f32 v27, v27
    v_exp_f32 v28, v28
    s_mov_b32 s6, 6291456
    buffer_load_dwordx4 v[176:179], v183, s[8:11], s6 offen sc1
    v_exp_f32 v29, v29
    v_exp_f32 v30, v30
    v_exp_f32 v31, v31
    s_setprio 0
    v_exp_f32 v32, v32
    v_exp_f32 v33, v33
    v_smfmac_f32_32x32x32_bf16 v[64:79], v[92:95], v[24:31], v100
    v_exp_f32 v34, v34
    v_exp_f32 v35, v35
    s_waitcnt lgkmcnt(2)
    v_mfma_f32_32x32x16_bf16 v[16:31], v[80:83], v[84:87], v[48:63]
    ds_read_b128 v[80:83], v180 offset:29696
    v_exp_f32 v36, v36
    v_exp_f32 v37, v37
    v_exp_f32 v38, v38
    v_exp_f32 v39, v39
    v_exp_f32 v40, v40
    v_exp_f32 v41, v41
    s_waitcnt lgkmcnt(1)
    v_smfmac_f32_32x32x32_bf16 v[64:79], v[88:91], v[32:39], v100
    s_mov_b64 exec, s[64:65]
    ds_read_b128 v[88:91], v102 offset:28672
    ds_read_b128 v[92:95], v102 offset:29184
    s_mov_b64 exec, -1
    v_exp_f32 v42, v42
    v_exp_f32 v43, v43
    v_exp_f32 v44, v44
    v_exp_f32 v45, v45
    v_exp_f32 v46, v46
    v_exp_f32 v47, v47
    s_setprio 3
    v_exp_f32 v16, v16
    v_exp_f32 v17, v17
    v_smfmac_f32_32x32x32_bf16 v[64:79], v[96:99], v[40:47], v100
    v_exp_f32 v18, v18
    v_exp_f32 v19, v19
    s_waitcnt lgkmcnt(2)
    v_mfma_f32_32x32x16_bf16 v[32:47], v[80:83], v[84:87], v[48:63]
    ds_read_b128 v[80:83], v180 offset:30720
    v_exp_f32 v20, v20
    v_exp_f32 v21, v21
    v_exp_f32 v22, v22
    v_exp_f32 v23, v23
    v_exp_f32 v24, v24
    v_exp_f32 v25, v25
    s_waitcnt lgkmcnt(1)
    v_smfmac_f32_32x32x32_bf16 v[64:79], v[88:91], v[16:23], v100
    s_mov_b64 exec, s[64:65]
    ds_read_b128 v[88:91], v102 offset:29696
    ds_read_b128 v[96:99], v102 offset:30208
    s_mov_b64 exec, -1
    v_exp_f32 v26, v26
    v_exp_f32 v27, v27
    v_exp_f32 v28, v28
    v_exp_f32 v29, v29
    v_exp_f32 v30, v30
    v_exp_f32 v31, v31
    s_setprio 2
    v_exp_f32 v32, v32
    v_exp_f32 v33, v33
    v_smfmac_f32_32x32x32_bf16 v[64:79], v[92:95], v[24:31], v100
    v_exp_f32 v34, v34
    v_exp_f32 v35, v35
    s_waitcnt lgkmcnt(2)
    v_mfma_f32_32x32x16_bf16 v[16:31], v[80:83], v[84:87], v[48:63]
    ds_read_b128 v[80:83], v180 offset:31744
    v_exp_f32 v36, v36
    v_exp_f32 v37, v37
    v_exp_f32 v38, v38
    v_exp_f32 v39, v39
    v_exp_f32 v40, v40
    v_exp_f32 v41, v41
    s_waitcnt lgkmcnt(1)
    v_smfmac_f32_32x32x32_bf16 v[64:79], v[88:91], v[32:39], v100
    s_mov_b64 exec, s[64:65]
    ds_read_b128 v[88:91], v102 offset:30720
    ds_read_b128 v[92:95], v102 offset:31232
    s_mov_b64 exec, -1
    v_exp_f32 v42, v42
    v_exp_f32 v43, v43
    v_exp_f32 v44, v44
    v_exp_f32 v45, v45
    v_exp_f32 v46, v46
    v_exp_f32 v47, v47
    s_waitcnt vmcnt(1)
    s_barrier
    s_setprio 1
    v_exp_f32 v16, v16
    v_exp_f32 v17, v17
    v_smfmac_f32_32x32x32_bf16 v[64:79], v[96:99], v[40:47], v100
    v_exp_f32 v18, v18
    v_exp_f32 v19, v19
    s_waitcnt lgkmcnt(2)
    v_mfma_f32_32x32x16_bf16 v[32:47], v[80:83], v[84:87], v[48:63]
    ds_read_b128 v[80:83], v180 offset:32768
    v_exp_f32 v20, v20
    v_exp_f32 v21, v21
    v_exp_f32 v22, v22
    v_exp_f32 v23, v23
    v_exp_f32 v24, v24
    v_exp_f32 v25, v25
    s_waitcnt lgkmcnt(1)
    v_smfmac_f32_32x32x32_bf16 v[64:79], v[88:91], v[16:23], v100
    s_mov_b64 exec, s[64:65]
    ds_read_b128 v[88:91], v102 offset:31744
    ds_read_b128 v[96:99], v102 offset:32256
    s_mov_b64 exec, -1
    v_exp_f32 v26, v26
    v_exp_f32 v27, v27
    v_exp_f32 v28, v28
    v_mov_b32 v4, -1
    v_mov_b32 v5, -1
    v_mov_b32 v6, -1
    v_mov_b32 v7, -1
    buffer_store_dwordx4 v[4:7], v180, s[8:11], s78 offen sc1
    v_exp_f32 v29, v29
    v_exp_f32 v30, v30
    v_exp_f32 v31, v31
    s_setprio 0
    v_exp_f32 v32, v32
    v_exp_f32 v33, v33
    v_smfmac_f32_32x32x32_bf16 v[64:79], v[92:95], v[24:31], v100
    v_exp_f32 v34, v34
    v_exp_f32 v35, v35
    s_waitcnt lgkmcnt(2)
    v_mfma_f32_32x32x16_bf16 v[16:31], v[80:83], v[84:87], v[48:63]
    ds_read_b128 v[80:83], v180 offset:33792
    v_exp_f32 v36, v36
    v_exp_f32 v37, v37
    v_exp_f32 v38, v38
    v_exp_f32 v39, v39
    v_exp_f32 v40, v40
    v_exp_f32 v41, v41
    s_waitcnt lgkmcnt(1)
    v_smfmac_f32_32x32x32_bf16 v[64:79], v[88:91], v[32:39], v100
    s_mov_b64 exec, s[64:65]
    ds_read_b128 v[88:91], v102 offset:32768
    ds_read_b128 v[92:95], v102 offset:33280
    s_mov_b64 exec, -1
    v_exp_f32 v42, v42
    v_exp_f32 v43, v43
    v_exp_f32 v44, v44
    s_lshl_b32 s6, s68, 3
    s_add_u32 s6, s6, s3
    s_lshl_b32 s6, s6, 12
    s_add_u32 s6, s6, 17301504
    buffer_load_dwordx2 v[10:11], v195, s[8:11], s6 offen sc1
    v_exp_f32 v45, v45
    v_exp_f32 v46, v46
    v_exp_f32 v47, v47
    s_setprio 3
    v_exp_f32 v16, v16
    v_exp_f32 v17, v17
    v_smfmac_f32_32x32x32_bf16 v[64:79], v[96:99], v[40:47], v100
    v_exp_f32 v18, v18
    v_exp_f32 v19, v19
    s_waitcnt lgkmcnt(2)
    v_mfma_f32_32x32x16_bf16 v[32:47], v[80:83], v[84:87], v[48:63]
    ds_read_b128 v[80:83], v180 offset:34816
    v_exp_f32 v20, v20
    v_exp_f32 v21, v21
    v_exp_f32 v22, v22
    v_exp_f32 v23, v23
    v_exp_f32 v24, v24
    v_exp_f32 v25, v25
    s_waitcnt lgkmcnt(1)
    v_smfmac_f32_32x32x32_bf16 v[64:79], v[88:91], v[16:23], v100
    s_mov_b64 exec, s[64:65]
    ds_read_b128 v[88:91], v102 offset:33792
    ds_read_b128 v[96:99], v102 offset:34304
    s_mov_b64 exec, -1
    v_exp_f32 v26, v26
    v_exp_f32 v27, v27
    v_exp_f32 v28, v28
    s_add_u32 m0, s66, 0
    s_mov_b32 s6, 0
    buffer_load_dwordx4 v184, s[48:51], s6 offen lds
    v_exp_f32 v29, v29
    v_exp_f32 v30, v30
    v_exp_f32 v31, v31
    s_setprio 2
    v_exp_f32 v32, v32
    v_exp_f32 v33, v33
    v_smfmac_f32_32x32x32_bf16 v[64:79], v[92:95], v[24:31], v100
    v_exp_f32 v34, v34
    v_exp_f32 v35, v35
    s_waitcnt lgkmcnt(2)
    v_mfma_f32_32x32x16_bf16 v[16:31], v[80:83], v[84:87], v[48:63]
    ds_read_b128 v[80:83], v180 offset:35840
    v_exp_f32 v36, v36
    v_exp_f32 v37, v37
    v_exp_f32 v38, v38
    v_exp_f32 v39, v39
    v_exp_f32 v40, v40
    v_exp_f32 v41, v41
    s_waitcnt lgkmcnt(1)
    v_smfmac_f32_32x32x32_bf16 v[64:79], v[88:91], v[32:39], v100
    s_mov_b64 exec, s[64:65]
    ds_read_b128 v[88:91], v102 offset:34816
    ds_read_b128 v[92:95], v102 offset:35328
    s_mov_b64 exec, -1
    v_exp_f32 v42, v42
    v_exp_f32 v43, v43
    v_exp_f32 v44, v44
    ds_read_b128 v[244:247], v108 offset:8192
    v_exp_f32 v45, v45
    v_exp_f32 v46, v46
    v_exp_f32 v47, v47
    s_setprio 1
    v_exp_f32 v16, v16
    v_exp_f32 v17, v17
    v_smfmac_f32_32x32x32_bf16 v[64:79], v[96:99], v[40:47], v100
    v_exp_f32 v18, v18
    v_exp_f32 v19, v19
    s_waitcnt lgkmcnt(3)
    v_mfma_f32_32x32x16_bf16 v[32:47], v[80:83], v[84:87], v[48:63]
    ds_read_b128 v[80:83], v180 offset:36864
    v_exp_f32 v20, v20
    v_exp_f32 v21, v21
    v_exp_f32 v22, v22
    v_exp_f32 v23, v23
    v_exp_f32 v24, v24
    v_exp_f32 v25, v25
    s_waitcnt lgkmcnt(2)
    v_smfmac_f32_32x32x32_bf16 v[64:79], v[88:91], v[16:23], v100
    s_mov_b64 exec, s[64:65]
    ds_read_b128 v[88:91], v102 offset:35840
    ds_read_b128 v[96:99], v102 offset:36352
    s_mov_b64 exec, -1
    v_exp_f32 v26, v26
    v_exp_f32 v27, v27
    v_exp_f32 v28, v28
    s_add_u32 m0, s66, 65536
    s_mov_b32 s6, 0
    buffer_load_dwordx4 v184, s[52:55], s6 offen lds
    s_waitcnt vmcnt(4) lgkmcnt(3)
    v_mfma_f32_32x32x16_bf16 v[112:127], v[244:247], v[176:179], v[128:143]
    v_exp_f32 v29, v29
    v_exp_f32 v30, v30
    v_exp_f32 v31, v31
    s_setprio 0
    v_exp_f32 v32, v32
    v_exp_f32 v33, v33
    v_smfmac_f32_32x32x32_bf16 v[64:79], v[92:95], v[24:31], v100
    v_exp_f32 v34, v34
    v_exp_f32 v35, v35
    s_waitcnt lgkmcnt(2)
    v_mfma_f32_32x32x16_bf16 v[16:31], v[80:83], v[84:87], v[48:63]
    ds_read_b128 v[80:83], v180 offset:37888
    v_exp_f32 v36, v36
    v_exp_f32 v37, v37
    v_exp_f32 v38, v38
    v_exp_f32 v39, v39
    v_exp_f32 v40, v40
    v_exp_f32 v41, v41
    s_waitcnt lgkmcnt(1)
    v_smfmac_f32_32x32x32_bf16 v[64:79], v[88:91], v[32:39], v100
    s_mov_b64 exec, s[64:65]
    ds_read_b128 v[88:91], v102 offset:36864
    ds_read_b128 v[92:95], v102 offset:37376
    s_mov_b64 exec, -1
    v_exp_f32 v42, v42
    v_exp_f32 v43, v43
    v_exp_f32 v44, v44
    v_max3_f32 v103, v112, v113, v114
    v_max3_f32 v105, v115, v116, v117
    v_max3_f32 v103, v103, v118, v119
    v_max3_f32 v105, v105, v120, v121
    v_max3_f32 v103, v103, v122, v123
    v_max3_f32 v105, v105, v124, v125
    v_max3_f32 v103, v103, v126, v127
    v_max_f32 v103, v103, v105
    v_mov_b32 v105, v103
    s_nop 1
    v_permlane32_swap_b32 v103, v105
    v_max_f32 v103, v103, v105
    v_sub_f32 v106, 0, v103
    v_sub_f32 v107, 0, v103
    v_exp_f32 v45, v45
    v_exp_f32 v46, v46
    v_exp_f32 v47, v47
    s_setprio 3
    v_exp_f32 v16, v16
    v_exp_f32 v17, v17
    v_smfmac_f32_32x32x32_bf16 v[64:79], v[96:99], v[40:47], v100
    v_exp_f32 v18, v18
    v_exp_f32 v19, v19
    s_waitcnt lgkmcnt(2)
    v_mfma_f32_32x32x16_bf16 v[32:47], v[80:83], v[84:87], v[48:63]
    ds_read_b128 v[80:83], v180 offset:38912
    v_exp_f32 v20, v20
    v_exp_f32 v21, v21
    v_exp_f32 v22, v22
    v_exp_f32 v23, v23
    v_exp_f32 v24, v24
    v_exp_f32 v25, v25
    s_waitcnt lgkmcnt(1)
    v_smfmac_f32_32x32x32_bf16 v[64:79], v[88:91], v[16:23], v100
    s_mov_b64 exec, s[64:65]
    ds_read_b128 v[88:91], v102 offset:37888
    ds_read_b128 v[96:99], v102 offset:38400
    s_mov_b64 exec, -1
    v_exp_f32 v26, v26
    v_exp_f32 v27, v27
    v_exp_f32 v28, v28
    s_add_u32 m0, s66, 8192
    s_mov_b32 s6, 65536
    buffer_load_dwordx4 v184, s[48:51], s6 offen lds
    v_pk_add_f32 v[128:129], v[128:129], v[106:107]
    v_pk_add_f32 v[130:131], v[130:131], v[106:107]
    v_pk_add_f32 v[132:133], v[132:133], v[106:107]
    v_pk_add_f32 v[134:135], v[134:135], v[106:107]
    v_pk_add_f32 v[136:137], v[136:137], v[106:107]
    v_pk_add_f32 v[138:139], v[138:139], v[106:107]
    v_pk_add_f32 v[140:141], v[140:141], v[106:107]
    v_pk_add_f32 v[142:143], v[142:143], v[106:107]
    v_exp_f32 v29, v29
    v_exp_f32 v30, v30
    v_exp_f32 v31, v31
    s_setprio 2
    v_exp_f32 v32, v32
    v_exp_f32 v33, v33
    v_smfmac_f32_32x32x32_bf16 v[64:79], v[92:95], v[24:31], v100
    v_exp_f32 v34, v34
    v_exp_f32 v35, v35
    s_waitcnt lgkmcnt(2)
    v_mfma_f32_32x32x16_bf16 v[16:31], v[80:83], v[84:87], v[48:63]
    ds_read_b128 v[80:83], v180 offset:39936
    v_exp_f32 v36, v36
    v_exp_f32 v37, v37
    v_exp_f32 v38, v38
    v_exp_f32 v39, v39
    v_exp_f32 v40, v40
    v_exp_f32 v41, v41
    s_waitcnt lgkmcnt(1)
    v_smfmac_f32_32x32x32_bf16 v[64:79], v[88:91], v[32:39], v100
    s_mov_b64 exec, s[64:65]
    ds_read_b128 v[88:91], v102 offset:38912
    ds_read_b128 v[92:95], v102 offset:39424
    s_mov_b64 exec, -1
    v_exp_f32 v42, v42
    v_exp_f32 v43, v43
    v_exp_f32 v44, v44
    v_pk_mov_b32 v[160:161], v[106:107], v[106:107]
    v_pk_mov_b32 v[162:163], v[106:107], v[106:107]
    v_pk_mov_b32 v[164:165], v[106:107], v[106:107]
    v_pk_mov_b32 v[166:167], v[106:107], v[106:107]
    v_pk_mov_b32 v[168:169], v[106:107], v[106:107]
    v_pk_mov_b32 v[170:171], v[106:107], v[106:107]
    v_pk_mov_b32 v[172:173], v[106:107], v[106:107]
    v_pk_mov_b32 v[174:175], v[106:107], v[106:107]
    v_exp_f32 v45, v45
    v_exp_f32 v46, v46
    v_exp_f32 v47, v47
    s_setprio 1
    v_exp_f32 v16, v16
    v_exp_f32 v17, v17
    v_smfmac_f32_32x32x32_bf16 v[64:79], v[96:99], v[40:47], v100
    v_exp_f32 v18, v18
    v_exp_f32 v19, v19
    s_waitcnt lgkmcnt(2)
    v_mfma_f32_32x32x16_bf16 v[32:47], v[80:83], v[84:87], v[48:63]
    ds_read_b128 v[80:83], v108 offset:8192
    v_exp_f32 v20, v20
    v_exp_f32 v21, v21
    v_exp_f32 v22, v22
    v_exp_f32 v23, v23
    v_exp_f32 v24, v24
    v_exp_f32 v25, v25
    s_waitcnt lgkmcnt(1)
    v_smfmac_f32_32x32x32_bf16 v[64:79], v[88:91], v[16:23], v100
    s_mov_b64 exec, s[64:65]
    ds_read_b128 v[88:91], v102 offset:39936
    ds_read_b128 v[96:99], v102 offset:40448
    s_mov_b64 exec, -1
    v_exp_f32 v26, v26
    v_exp_f32 v27, v27
    v_exp_f32 v28, v28
    s_add_u32 m0, s66, 73728
    s_mov_b32 s6, 65536
    buffer_load_dwordx4 v184, s[52:55], s6 offen lds
    v_pk_add_f32 v[144:145], v[144:145], v[106:107]
    v_pk_add_f32 v[146:147], v[146:147], v[106:107]
    v_pk_add_f32 v[148:149], v[148:149], v[106:107]
    v_pk_add_f32 v[150:151], v[150:151], v[106:107]
    v_pk_add_f32 v[152:153], v[152:153], v[106:107]
    v_pk_add_f32 v[154:155], v[154:155], v[106:107]
    v_pk_add_f32 v[156:157], v[156:157], v[106:107]
    v_pk_add_f32 v[158:159], v[158:159], v[106:107]
    v_exp_f32 v29, v29
    v_exp_f32 v30, v30
    v_exp_f32 v31, v31
    s_setprio 0
    v_exp_f32 v32, v32
    v_exp_f32 v33, v33
    v_smfmac_f32_32x32x32_bf16 v[64:79], v[92:95], v[24:31], v100
    v_exp_f32 v34, v34
    v_exp_f32 v35, v35
    s_waitcnt lgkmcnt(2)
    v_mfma_f32_32x32x16_bf16 v[16:31], v[80:83], v[176:179], v[128:143]
    ds_read_b128 v[80:83], v108 offset:7168
    v_exp_f32 v36, v36
    v_exp_f32 v37, v37
    v_exp_f32 v38, v38
    v_exp_f32 v39, v39
    v_exp_f32 v40, v40
    v_exp_f32 v41, v41
    s_waitcnt lgkmcnt(1)
    v_smfmac_f32_32x32x32_bf16 v[64:79], v[88:91], v[32:39], v100
    s_mov_b64 exec, s[64:65]
    ds_read_b128 v[88:91], v109 offset:8192
    ds_read_b128 v[92:95], v109 offset:8704
    s_mov_b64 exec, -1
    v_exp_f32 v42, v42
    v_exp_f32 v43, v43
    v_exp_f32 v44, v44
    v_exp_f32 v45, v45
    v_exp_f32 v46, v46
    v_exp_f32 v47, v47
    s_setprio 3
    v_exp_f32 v16, v16
    v_exp_f32 v17, v17
    v_smfmac_f32_32x32x32_bf16 v[64:79], v[96:99], v[40:47], v100
    v_exp_f32 v18, v18
    v_exp_f32 v19, v19
    s_cmp_eq_u32 s74, 0
    s_cbranch_scc1 L_B_k0
L_B_sk0:
    s_waitcnt lgkmcnt(2)
    v_mfma_f32_32x32x16_bf16 v[32:47], v[80:83], v[176:179], v[160:175]
    ds_read_b128 v[80:83], v108 offset:6144
    v_exp_f32 v20, v20
    v_exp_f32 v21, v21
    v_exp_f32 v22, v22
    v_exp_f32 v23, v23
    v_exp_f32 v24, v24
    v_exp_f32 v25, v25
    s_waitcnt lgkmcnt(1)
    v_smfmac_f32_32x32x32_bf16 v[228:243], v[88:91], v[16:23], v100
    s_mov_b64 exec, s[64:65]
    ds_read_b128 v[88:91], v109 offset:7168
    ds_read_b128 v[96:99], v109 offset:7680
    s_mov_b64 exec, -1
    v_exp_f32 v26, v26
    v_exp_f32 v27, v27
    v_exp_f32 v28, v28
    s_add_u32 m0, s66, 16384
    s_mov_b32 s6, 131072
    buffer_load_dwordx4 v184, s[48:51], s6 offen lds
    v_exp_f32 v29, v29
    v_exp_f32 v30, v30
    v_exp_f32 v31, v31
    s_setprio 2
    v_exp_f32 v32, v32
    v_exp_f32 v33, v33
    v_smfmac_f32_32x32x32_bf16 v[228:243], v[92:95], v[24:31], v100
    v_exp_f32 v34, v34
    v_exp_f32 v35, v35
    s_cmp_eq_u32 s74, 1
    s_cbranch_scc1 L_B_k1
L_B_sk1:
    s_waitcnt lgkmcnt(2)
    v_mfma_f32_32x32x16_bf16 v[16:31], v[80:83], v[176:179], v[160:175]
    ds_read_b128 v[80:83], v108 offset:5120
    v_exp_f32 v36, v36
    v_exp_f32 v37, v37
    v_exp_f32 v38, v38
    v_exp_f32 v39, v39
    v_exp_f32 v40, v40
    v_exp_f32 v41, v41
    s_waitcnt lgkmcnt(1)
    v_smfmac_f32_32x32x32_bf16 v[228:243], v[88:91], v[32:39], v100
    s_mov_b64 exec, s[64:65]
    ds_read_b128 v[88:91], v109 offset:6144
    ds_read_b128 v[92:95], v109 offset:6656
    s_mov_b64 exec, -1
    v_exp_f32 v42, v42
    v_exp_f32 v43, v43
    v_exp_f32 v44, v44
    v_exp_f32 v45, v45
    v_exp_f32 v46, v46
    v_exp_f32 v47, v47
    s_setprio 1
    v_exp_f32 v16, v16
    v_exp_f32 v17, v17
    v_smfmac_f32_32x32x32_bf16 v[228:243], v[96:99], v[40:47], v100
    v_exp_f32 v18, v18
    v_exp_f32 v19, v19
    s_cmp_eq_u32 s74, 2
    s_cbranch_scc1 L_B_k2
L_B_sk2:
    s_waitcnt lgkmcnt(2)
    v_mfma_f32_32x32x16_bf16 v[32:47], v[80:83], v[176:179], v[160:175]
    ds_read_b128 v[80:83], v108 offset:4096
    v_exp_f32 v20, v20
    v_exp_f32 v21, v21
    v_exp_f32 v22, v22
    v_exp_f32 v23, v23
    v_exp_f32 v24, v24
    v_exp_f32 v25, v25
    s_waitcnt lgkmcnt(1)
    v_smfmac_f32_32x32x32_bf16 v[228:243], v[88:91], v[16:23], v100
    s_mov_b64 exec, s[64:65]
    ds_read_b128 v[88:91], v109 offset:5120
    ds_read_b128 v[96:99], v109 offset:5632
    s_mov_b64 exec, -1
    v_exp_f32 v26, v26
    v_exp_f32 v27, v27
    v_exp_f32 v28, v28
    s_add_u32 m0, s66, 81920
    s_mov_b32 s6, 131072
    buffer_load_dwordx4 v184, s[52:55], s6 offen lds
    v_exp_f32 v29, v29
    v_exp_f32 v30, v30
    v_exp_f32 v31, v31
    s_setprio 0
    v_exp_f32 v32, v32
    v_exp_f32 v33, v33
    v_smfmac_f32_32x32x32_bf16 v[228:243], v[92:95], v[24:31], v100
    v_exp_f32 v34, v34
    v_exp_f32 v35, v35
    s_cmp_eq_u32 s74, 3
    s_cbranch_scc1 L_B_k3
L_B_sk3:
    s_waitcnt lgkmcnt(2)
    v_mfma_f32_32x32x16_bf16 v[16:31], v[80:83], v[176:179], v[160:175]
    ds_read_b128 v[80:83], v108 offset:3072
    v_exp_f32 v36, v36
    v_exp_f32 v37, v37
    v_exp_f32 v38, v38
    v_exp_f32 v39, v39
    v_exp_f32 v40, v40
    v_exp_f32 v41, v41
    s_waitcnt lgkmcnt(1)
    v_smfmac_f32_32x32x32_bf16 v[228:243], v[88:91], v[32:39], v100
    s_mov_b64 exec, s[64:65]
    ds_read_b128 v[88:91], v109 offset:4096
    ds_read_b128 v[92:95], v109 offset:4608
    s_mov_b64 exec, -1
    v_exp_f32 v42, v42
    v_exp_f32 v43, v43
    v_exp_f32 v44, v44
    v_exp_f32 v45, v45
    v_exp_f32 v46, v46
    v_exp_f32 v47, v47
    s_setprio 3
    v_exp_f32 v16, v16
    v_exp_f32 v17, v17
    v_smfmac_f32_32x32x32_bf16 v[228:243], v[96:99], v[40:47], v100
    v_exp_f32 v18, v18
    v_exp_f32 v19, v19
    s_cmp_eq_u32 s74, 4
    s_cbranch_scc1 L_B_k4
L_B_sk4:
    s_waitcnt lgkmcnt(2)
    v_mfma_f32_32x32x16_bf16 v[32:47], v[80:83], v[176:179], v[160:175]
    ds_read_b128 v[80:83], v108 offset:2048
    v_exp_f32 v20, v20
    v_exp_f32 v21, v21
    v_exp_f32 v22, v22
    v_exp_f32 v23, v23
    v_exp_f32 v24, v24
    v_exp_f32 v25, v25
    s_waitcnt lgkmcnt(1)
    v_smfmac_f32_32x32x32_bf16 v[228:243], v[88:91], v[16:23], v100
    s_mov_b64 exec, s[64:65]
    ds_read_b128 v[88:91], v109 offset:3072
    ds_read_b128 v[96:99], v109 offset:3584
    s_mov_b64 exec, -1
    v_exp_f32 v26, v26
    v_exp_f32 v27, v27
    v_exp_f32 v28, v28
    s_waitcnt vmcnt(6)
    v_cmp_ne_u32 vcc, s85, v10
    s_cbranch_vccnz L_g_spin
L_g_go:
    v_sub_f32 v10, 1.0, v11
    v_cvt_pk_bf16_f32 v10, v10, v10
    v_lshlrev_b32 v10, 16, v10
    v_exp_f32 v29, v29
    v_exp_f32 v30, v30
    v_exp_f32 v31, v31
    s_setprio 2
    v_exp_f32 v32, v32
    v_exp_f32 v33, v33
    v_smfmac_f32_32x32x32_bf16 v[228:243], v[92:95], v[24:31], v100
    v_exp_f32 v34, v34
    v_exp_f32 v35, v35
    s_cmp_eq_u32 s74, 5
    s_cbranch_scc1 L_B_k5
L_B_sk5:
    s_waitcnt lgkmcnt(2)
    v_mfma_f32_32x32x16_bf16 v[16:31], v[80:83], v[176:179], v[160:175]
    ds_read_b128 v[80:83], v108 offset:1024
    v_exp_f32 v36, v36
    v_exp_f32 v37, v37
    v_exp_f32 v38, v38
    v_exp_f32 v39, v39
    v_exp_f32 v40, v40
    v_exp_f32 v41, v41
    s_waitcnt lgkmcnt(1)
    v_smfmac_f32_32x32x32_bf16 v[228:243], v[88:91], v[32:39], v100
    s_mov_b64 exec, s[64:65]
    ds_read_b128 v[88:91], v109 offset:2048
    ds_read_b128 v[92:95], v109 offset:2560
    s_mov_b64 exec, -1
    v_exp_f32 v42, v42
    v_exp_f32 v43, v43
    v_exp_f32 v44, v44
    v_exp_f32 v45, v45
    v_exp_f32 v46, v46
    v_exp_f32 v47, v47
    s_setprio 1
    v_exp_f32 v16, v16
    v_exp_f32 v17, v17
    v_smfmac_f32_32x32x32_bf16 v[228:243], v[96:99], v[40:47], v100
    v_exp_f32 v18, v18
    v_exp_f32 v19, v19
    s_cmp_eq_u32 s74, 6
    s_cbranch_scc1 L_B_k6
L_B_sk6:
    s_waitcnt lgkmcnt(2)
    v_mfma_f32_32x32x16_bf16 v[32:47], v[80:83], v[176:179], v[160:175]
    ds_read_b128 v[80:83], v108 offset:0
    v_exp_f32 v20, v20
    v_exp_f32 v21, v21
    v_exp_f32 v22, v22
    v_exp_f32 v23, v23
    v_exp_f32 v24, v24
    v_exp_f32 v25, v25
    s_waitcnt lgkmcnt(1)
    v_smfmac_f32_32x32x32_bf16 v[228:243], v[88:91], v[16:23], v100
    s_mov_b64 exec, s[64:65]
    ds_read_b128 v[88:91], v109 offset:1024
    ds_read_b128 v[96:99], v109 offset:1536
    s_mov_b64 exec, -1
    v_exp_f32 v26, v26
    v_exp_f32 v27, v27
    v_exp_f32 v28, v28
    v_exp_f32 v29, v29
    v_exp_f32 v30, v30
    v_exp_f32 v31, v31
    s_setprio 0
    v_exp_f32 v32, v32
    v_exp_f32 v33, v33
    v_smfmac_f32_32x32x32_bf16 v[228:243], v[92:95], v[24:31], v100
    v_exp_f32 v34, v34
    v_exp_f32 v35, v35
    s_cmp_eq_u32 s74, 7
    s_cbranch_scc1 L_B_k7
L_B_sk7:
    s_waitcnt lgkmcnt(2)
    v_mfma_f32_32x32x16_bf16 v[16:31], v[80:83], v[176:179], v[144:159]
    ds_read_b128 v[80:83], v180 offset:40960
    v_exp_f32 v36, v36
    v_exp_f32 v37, v37
    v_exp_f32 v38, v38
    v_exp_f32 v39, v39
    v_exp_f32 v40, v40
    v_exp_f32 v41, v41
    s_waitcnt lgkmcnt(1)
    v_smfmac_f32_32x32x32_bf16 v[228:243], v[88:91], v[32:39], v100
    s_mov_b64 exec, s[64:65]
    ds_read_b128 v[88:91], v109 offset:0
    ds_read_b128 v[92:95], v109 offset:512
    s_mov_b64 exec, -1
    v_exp_f32 v42, v42
    v_exp_f32 v43, v43
    v_exp_f32 v44, v44
    v_exp_f32 v45, v45
    v_exp_f32 v46, v46
    v_exp_f32 v47, v47
    s_setprio 3
    v_exp_f32 v16, v16
    v_exp_f32 v17, v17
    v_smfmac_f32_32x32x32_bf16 v[228:243], v[96:99], v[40:47], v100
    v_exp_f32 v18, v18
    v_exp_f32 v19, v19
    s_waitcnt lgkmcnt(2)
    v_mfma_f32_32x32x16_bf16 v[32:47], v[80:83], v[84:87], v[48:63]
    ds_read_b128 v[80:83], v180 offset:41984
    v_exp_f32 v20, v20
    v_exp_f32 v21, v21
    v_exp_f32 v22, v22
    v_exp_f32 v23, v23
    v_exp_f32 v24, v24
    v_exp_f32 v25, v25
    s_waitcnt lgkmcnt(1)
    v_smfmac_f32_32x32x32_bf16 v[228:243], v[88:91], v[16:23], v100
    s_mov_b64 exec, s[64:65]
    ds_read_b128 v[88:91], v102 offset:40960
    ds_read_b128 v[96:99], v102 offset:41472
    s_mov_b64 exec, -1
    v_exp_f32 v26, v26
    v_exp_f32 v27, v27
    v_exp_f32 v28, v28
    v_exp_f32 v29, v29
    v_exp_f32 v30, v30
    v_exp_f32 v31, v31
    s_setprio 2
    v_exp_f32 v32, v32
    v_exp_f32 v33, v33
    v_smfmac_f32_32x32x32_bf16 v[228:243], v[92:95], v[24:31], v100
    v_exp_f32 v34, v34
    v_exp_f32 v35, v35
    s_waitcnt lgkmcnt(2)
    v_mfma_f32_32x32x16_bf16 v[16:31], v[80:83], v[84:87], v[48:63]
    ds_read_b128 v[80:83], v180 offset:43008
    v_exp_f32 v36, v36
    v_exp_f32 v37, v37
    v_exp_f32 v38, v38
    v_exp_f32 v39, v39
    v_exp_f32 v40, v40
    v_exp_f32 v41, v41
    s_waitcnt lgkmcnt(1)
    v_smfmac_f32_32x32x32_bf16 v[64:79], v[88:91], v[32:39], v100
    s_mov_b64 exec, s[64:65]
    ds_read_b128 v[88:91], v102 offset:41984
    ds_read_b128 v[92:95], v102 offset:42496
    s_mov_b64 exec, -1
    v_exp_f32 v42, v42
    v_exp_f32 v43, v43
    v_exp_f32 v44, v44
    v_exp_f32 v45, v45
    v_exp_f32 v46, v46
    v_exp_f32 v47, v47
    s_add_u32 s70, s78, 2097152
    v_rcp_f32 v106, v236
    v_max3_f32 v104, abs(v228), abs(v229), abs(v230)
    v_max3_f32 v105, abs(v231), abs(v232), abs(v233)
    v_cmp_gt_f32 vcc, 0x5f800000, v236
    v_max3_f32 v104, v104, abs(v234), abs(v235)
    s_mov_b32 s7, 0x7f800000
    v_max_f32 v104, v104, v105
    v_cmp_gt_f32 s[72:73], s7, v104
L_ok_B:
    v_mul_f32 v106, v106, v10
    v_pk_mul_f32 v[228:229], v[228:229], v[106:107] op_sel_hi:[1,0]
    v_pk_mul_f32 v[230:231], v[230:231], v[106:107] op_sel_hi:[1,0]
    v_pk_mul_f32 v[232:233], v[232:233], v[106:107] op_sel_hi:[1,0]
    v_pk_mul_f32 v[234:235], v[234:235], v[106:107] op_sel_hi:[1,0]
    s_and_b64 s[72:73], s[72:73], vcc
    v_cvt_pk_bf16_f32 v236, v228, v229
    v_cvt_pk_bf16_f32 v237, v230, v231
    v_cvt_pk_bf16_f32 v238, v232, v233
    v_cvt_pk_bf16_f32 v239, v234, v235
    s_cmp_eq_u64 s[72:73], -1
    s_cbranch_scc0 L_fb_B
    buffer_store_dwordx4 v[236:239], v180, s[8:11], s70 offen sc1
    s_setprio 1
    v_exp_f32 v16, v16
    v_exp_f32 v17, v17
    v_smfmac_f32_32x32x32_bf16 v[64:79], v[96:99], v[40:47], v100
    v_exp_f32 v18, v18
    v_exp_f32 v19, v19
    s_waitcnt lgkmcnt(2)
    v_mfma_f32_32x32x16_bf16 v[32:47], v[80:83], v[84:87], v[48:63]
    ds_read_b128 v[80:83], v180 offset:44032
    v_exp_f32 v20, v20
    v_exp_f32 v21, v21
    v_exp_f32 v22, v22
    v_exp_f32 v23, v23
    v_exp_f32 v24, v24
    v_exp_f32 v25, v25
    s_waitcnt lgkmcnt(1)
    v_smfmac_f32_32x32x32_bf16 v[64:79], v[88:91], v[16:23], v100
    s_mov_b64 exec, s[64:65]
    ds_read_b128 v[88:91], v102 offset:43008
    ds_read_b128 v[96:99], v102 offset:43520
    s_mov_b64 exec, -1
    v_exp_f32 v26, v26
    v_exp_f32 v27, v27
    v_exp_f32 v28, v28
    v_exp_f32 v29, v29
    v_exp_f32 v30, v30
    v_exp_f32 v31, v31
    s_setprio 0
    v_exp_f32 v32, v32
    v_exp_f32 v33, v33
    v_smfmac_f32_32x32x32_bf16 v[64:79], v[92:95], v[24:31], v100
    v_exp_f32 v34, v34
    v_exp_f32 v35, v35
    s_waitcnt lgkmcnt(2)
    v_mfma_f32_32x32x16_bf16 v[16:31], v[80:83], v[84:87], v[48:63]
    ds_read_b128 v[80:83], v180 offset:45056
    v_exp_f32 v36, v36
    v_exp_f32 v37, v37
    v_exp_f32 v38, v38
    v_exp_f32 v39, v39
    v_exp_f32 v40, v40
    v_exp_f32 v41, v41
    s_waitcnt lgkmcnt(1)
    v_smfmac_f32_32x32x32_bf16 v[64:79], v[88:91], v[32:39], v100
    s_mov_b64 exec, s[64:65]
    ds_read_b128 v[88:91], v102 offset:44032
    ds_read_b128 v[92:95], v102 offset:44544
    s_mov_b64 exec, -1
    v_exp_f32 v42, v42
    v_exp_f32 v43, v43
    v_exp_f32 v44, v44
    v_exp_f32 v45, v45
    v_exp_f32 v46, v46
    v_exp_f32 v47, v47
    s_setprio 3
    v_exp_f32 v16, v16
    v_exp_f32 v17, v17
    v_smfmac_f32_32x32x32_bf16 v[64:79], v[96:99], v[40:47], v100
    v_exp_f32 v18, v18
    v_exp_f32 v19, v19
    s_waitcnt lgkmcnt(2)
    v_mfma_f32_32x32x16_bf16 v[32:47], v[80:83], v[84:87], v[48:63]
    ds_read_b128 v[80:83], v180 offset:46080
    v_exp_f32 v20, v20
    v_exp_f32 v21, v21
    v_exp_f32 v22, v22
    v_exp_f32 v23, v23
    v_exp_f32 v24, v24
    v_exp_f32 v25, v25
    s_waitcnt lgkmcnt(1)
    v_smfmac_f32_32x32x32_bf16 v[64:79], v[88:91], v[16:23], v100
    s_mov_b64 exec, s[64:65]
    ds_read_b128 v[88:91], v102 offset:45056
    ds_read_b128 v[96:99], v102 offset:45568
    s_mov_b64 exec, -1
    v_exp_f32 v26, v26
    v_exp_f32 v27, v27
    v_exp_f32 v28, v28
    v_exp_f32 v29, v29
    v_exp_f32 v30, v30
    v_exp_f32 v31, v31
    s_setprio 2
    v_exp_f32 v32, v32
    v_exp_f32 v33, v33
    v_smfmac_f32_32x32x32_bf16 v[64:79], v[92:95], v[24:31], v100
    v_exp_f32 v34, v34
    v_exp_f32 v35, v35
    s_waitcnt lgkmcnt(2)
    v_mfma_f32_32x32x16_bf16 v[16:31], v[80:83], v[84:87], v[48:63]
    ds_read_b128 v[80:83], v180 offset:47104
    v_exp_f32 v36, v36
    v_exp_f32 v37, v37
    v_exp_f32 v38, v38
    v_exp_f32 v39, v39
    v_exp_f32 v40, v40
    v_exp_f32 v41, v41
    s_waitcnt lgkmcnt(1)
    v_smfmac_f32_32x32x32_bf16 v[64:79], v[88:91], v[32:39], v100
    s_mov_b64 exec, s[64:65]
    ds_read_b128 v[88:91], v102 offset:46080
    ds_read_b128 v[92:95], v102 offset:46592
    s_mov_b64 exec, -1
    v_exp_f32 v42, v42
    v_exp_f32 v43, v43
    v_exp_f32 v44, v44
    v_exp_f32 v45, v45
    v_exp_f32 v46, v46
    v_exp_f32 v47, v47
    s_setprio 1
    v_exp_f32 v16, v16
    v_exp_f32 v17, v17
    v_smfmac_f32_32x32x32_bf16 v[64:79], v[96:99], v[40:47], v100
    v_exp_f32 v18, v18
    v_exp_f32 v19, v19
    s_waitcnt lgkmcnt(2)
    v_mfma_f32_32x32x16_bf16 v[32:47], v[80:83], v[84:87], v[48:63]
    ds_read_b128 v[80:83], v180 offset:48128
    v_exp_f32 v20, v20
    v_exp_f32 v21, v21
    v_exp_f32 v22, v22
    v_exp_f32 v23, v23
    v_exp_f32 v24, v24
    v_exp_f32 v25, v25
    s_waitcnt lgkmcnt(1)
    v_smfmac_f32_32x32x32_bf16 v[64:79], v[88:91], v[16:23], v100
    s_mov_b64 exec, s[64:65]
    ds_read_b128 v[88:91], v102 offset:47104
    ds_read_b128 v[96:99], v102 offset:47616
    s_mov_b64 exec, -1
    v_exp_f32 v26, v26
    v_exp_f32 v27, v27
    v_exp_f32 v28, v28
    v_exp_f32 v29, v29
    v_exp_f32 v30, v30
    v_exp_f32 v31, v31
    s_setprio 0
    v_exp_f32 v32, v32
    v_exp_f32 v33, v33
    v_smfmac_f32_32x32x32_bf16 v[64:79], v[92:95], v[24:31], v100
    v_exp_f32 v34, v34
    v_exp_f32 v35, v35
    s_waitcnt lgkmcnt(2)
    v_mfma_f32_32x32x16_bf16 v[16:31], v[80:83], v[84:87], v[48:63]
    ds_read_b128 v[80:83], v180 offset:49152
    v_exp_f32 v36, v36
    v_exp_f32 v37, v37
    v_exp_f32 v38, v38
    v_exp_f32 v39, v39
    v_exp_f32 v40, v40
    v_exp_f32 v41, v41
    s_waitcnt lgkmcnt(1)
    v_smfmac_f32_32x32x32_bf16 v[64:79], v[88:91], v[32:39], v100
    s_mov_b64 exec, s[64:65]
    ds_read_b128 v[88:91], v102 offset:48128
    ds_read_b128 v[92:95], v102 offset:48640
    s_mov_b64 exec, -1
    v_exp_f32 v42, v42
    v_exp_f32 v43, v43
    v_exp_f32 v44, v44
    s_sub_u32 s6, s78, 12582912
    s_lshr_b32 s6, s6, 3
    s_add_u32 s6, s6, 17039360
    s_waitcnt vmcnt(0)
    v_mov_b32 v104, s85
    v_mov_b32 v105, s60
    v_mov_b32 v106, s85
    v_mov_b32 v107, s60
    s_mov_b64 exec, 0xff
    buffer_store_dwordx4 v[104:107], v180, s[8:11], s6 offen sc1
    s_mov_b64 exec, -1
    v_exp_f32 v45, v45
    v_exp_f32 v46, v46
    v_exp_f32 v47, v47
    s_setprio 3
    v_exp_f32 v16, v16
    v_exp_f32 v17, v17
    v_smfmac_f32_32x32x32_bf16 v[64:79], v[96:99], v[40:47], v100
    v_exp_f32 v18, v18
    v_exp_f32 v19, v19
    s_waitcnt lgkmcnt(2)
    v_mfma_f32_32x32x16_bf16 v[32:47], v[80:83], v[84:87], v[48:63]
    ds_read_b128 v[80:83], v180 offset:50176
    v_exp_f32 v20, v20
    v_exp_f32 v21, v21
    v_exp_f32 v22, v22
    v_exp_f32 v23, v23
    v_exp_f32 v24, v24
    v_exp_f32 v25, v25
    s_waitcnt lgkmcnt(1)
    v_smfmac_f32_32x32x32_bf16 v[64:79], v[88:91], v[16:23], v100
    s_mov_b64 exec, s[64:65]
    ds_read_b128 v[88:91], v102 offset:49152
    ds_read_b128 v[96:99], v102 offset:49664
    s_mov_b64 exec, -1
    v_exp_f32 v26, v26
    v_exp_f32 v27, v27
    v_exp_f32 v28, v28
    v_exp_f32 v29, v29
    v_exp_f32 v30, v30
    v_exp_f32 v31, v31
    s_barrier
    s_setprio 2
    v_exp_f32 v32, v32
    v_exp_f32 v33, v33
    v_smfmac_f32_32x32x32_bf16 v[64:79], v[92:95], v[24:31], v100
    v_exp_f32 v34, v34
    v_exp_f32 v35, v35
    s_waitcnt lgkmcnt(2)
    v_mfma_f32_32x32x16_bf16 v[16:31], v[80:83], v[84:87], v[48:63]
    ds_read_b128 v[80:83], v180 offset:51200
    v_exp_f32 v36, v36
    v_exp_f32 v37, v37
    v_exp_f32 v38, v38
    v_exp_f32 v39, v39
    v_exp_f32 v40, v40
    v_exp_f32 v41, v41
    s_waitcnt lgkmcnt(1)
    v_smfmac_f32_32x32x32_bf16 v[64:79], v[88:91], v[32:39], v100
    s_mov_b64 exec, s[64:65]
    ds_read_b128 v[88:91], v102 offset:50176
    ds_read_b128 v[92:95], v102 offset:50688
    s_mov_b64 exec, -1
    v_exp_f32 v42, v42
    v_exp_f32 v43, v43
    v_exp_f32 v44, v44
    s_add_u32 m0, s66, 24576
    s_mov_b32 s6, 196608
    buffer_load_dwordx4 v184, s[48:51], s6 offen lds
    s_add_u32 m0, s66, 90112
    s_mov_b32 s6, 196608
    buffer_load_dwordx4 v184, s[52:55], s6 offen lds
    v_exp_f32 v45, v45
    v_exp_f32 v46, v46
    v_exp_f32 v47, v47
    s_setprio 1
    v_exp_f32 v16, v16
    v_exp_f32 v17, v17
    v_smfmac_f32_32x32x32_bf16 v[64:79], v[96:99], v[40:47], v100
    v_exp_f32 v18, v18
    v_exp_f32 v19, v19
    s_waitcnt lgkmcnt(2)
    v_mfma_f32_32x32x16_bf16 v[32:47], v[80:83], v[84:87], v[48:63]
    ds_read_b128 v[80:83], v180 offset:52224
    v_exp_f32 v20, v20
    v_exp_f32 v21, v21
    v_exp_f32 v22, v22
    v_exp_f32 v23, v23
    v_exp_f32 v24, v24
    v_exp_f32 v25, v25
    s_waitcnt lgkmcnt(1)
    v_smfmac_f32_32x32x32_bf16 v[64:79], v[88:91], v[16:23], v100
    s_mov_b64 exec, s[64:65]
    ds_read_b128 v[88:91], v102 offset:51200
    ds_read_b128 v[96:99], v102 offset:51712
    s_mov_b64 exec, -1
    v_exp_f32 v26, v26
    v_exp_f32 v27, v27
    v_exp_f32 v28, v28
    s_add_u32 m0, s66, 32768
    s_mov_b32 s6, 262144
    buffer_load_dwordx4 v184, s[48:51], s6 offen lds
    v_exp_f32 v29, v29
    v_exp_f32 v30, v30
    v_exp_f32 v31, v31
    s_setprio 0
    v_exp_f32 v32, v32
    v_exp_f32 v33, v33
    v_smfmac_f32_32x32x32_bf16 v[64:79], v[92:95], v[24:31], v100
    v_exp_f32 v34, v34
    v_exp_f32 v35, v35
    s_waitcnt lgkmcnt(2)
    v_mfma_f32_32x32x16_bf16 v[16:31], v[80:83], v[84:87], v[48:63]
    ds_read_b128 v[80:83], v180 offset:53248
    v_exp_f32 v36, v36
    v_exp_f32 v37, v37
    v_exp_f32 v38, v38
    v_exp_f32 v39, v39
    v_exp_f32 v40, v40
    v_exp_f32 v41, v41
    s_waitcnt lgkmcnt(1)
    v_smfmac_f32_32x32x32_bf16 v[64:79], v[88:91], v[32:39], v100
    s_mov_b64 exec, s[64:65]
    ds_read_b128 v[88:91], v102 offset:52224
    ds_read_b128 v[92:95], v102 offset:52736
    s_mov_b64 exec, -1
    v_exp_f32 v42, v42
    v_exp_f32 v43, v43
    v_exp_f32 v44, v44
    s_add_u32 m0, s66, 98304
    s_mov_b32 s6, 262144
    buffer_load_dwordx4 v184, s[52:55], s6 offen lds
    v_exp_f32 v45, v45
    v_exp_f32 v46, v46
    v_exp_f32 v47, v47
    s_setprio 3
    v_exp_f32 v16, v16
    v_exp_f32 v17, v17
    v_smfmac_f32_32x32x32_bf16 v[64:79], v[96:99], v[40:47], v100
    v_exp_f32 v18, v18
    v_exp_f32 v19, v19
    s_waitcnt lgkmcnt(2)
    v_mfma_f32_32x32x16_bf16 v[32:47], v[80:83], v[84:87], v[48:63]
    ds_read_b128 v[80:83], v180 offset:54272
    v_exp_f32 v20, v20
    v_exp_f32 v21, v21
    v_exp_f32 v22, v22
    v_exp_f32 v23, v23
    v_exp_f32 v24, v24
    v_exp_f32 v25, v25
    s_waitcnt lgkmcnt(1)
    v_smfmac_f32_32x32x32_bf16 v[64:79], v[88:91], v[16:23], v100
    s_mov_b64 exec, s[64:65]
    ds_read_b128 v[88:91], v102 offset:53248
    ds_read_b128 v[96:99], v102 offset:53760
    s_mov_b64 exec, -1
    v_exp_f32 v26, v26
    v_exp_f32 v27, v27
    v_exp_f32 v28, v28
    s_add_u32 m0, s66, 40960
    s_mov_b32 s6, 327680
    buffer_load_dwordx4 v184, s[48:51], s6 offen lds
    v_exp_f32 v29, v29
    v_exp_f32 v30, v30
    v_exp_f32 v31, v31
    s_setprio 2
    v_exp_f32 v32, v32
    v_exp_f32 v33, v33
    v_smfmac_f32_32x32x32_bf16 v[64:79], v[92:95], v[24:31], v100
    v_exp_f32 v34, v34
    v_exp_f32 v35, v35
    s_waitcnt lgkmcnt(2)
    v_mfma_f32_32x32x16_bf16 v[16:31], v[80:83], v[84:87], v[48:63]
    ds_read_b128 v[80:83], v180 offset:55296
    v_exp_f32 v36, v36
    v_exp_f32 v37, v37
    v_exp_f32 v38, v38
    v_exp_f32 v39, v39
    v_exp_f32 v40, v40
    v_exp_f32 v41, v41
    s_waitcnt lgkmcnt(1)
    v_smfmac_f32_32x32x32_bf16 v[64:79], v[88:91], v[32:39], v100
    s_mov_b64 exec, s[64:65]
    ds_read_b128 v[88:91], v102 offset:54272
    ds_read_b128 v[92:95], v102 offset:54784
    s_mov_b64 exec, -1
    v_exp_f32 v42, v42
    v_exp_f32 v43, v43
    v_exp_f32 v44, v44
    s_add_u32 m0, s66, 106496
    s_mov_b32 s6, 327680
    buffer_load_dwordx4 v184, s[52:55], s6 offen lds
    s_add_u32 m0, s66, 147456
    s_mov_b32 s6, 393216
    buffer_load_dwordx4 v184, s[52:55], s6 offen lds
    v_exp_f32 v45, v45
    v_exp_f32 v46, v46
    v_exp_f32 v47, v47
    s_setprio 1
    v_exp_f32 v16, v16
    v_exp_f32 v17, v17
    v_smfmac_f32_32x32x32_bf16 v[64:79], v[96:99], v[40:47], v100
    v_exp_f32 v18, v18
    v_exp_f32 v19, v19
    s_waitcnt lgkmcnt(2)
    v_mfma_f32_32x32x16_bf16 v[32:47], v[80:83], v[84:87], v[48:63]
    ds_read_b128 v[80:83], v180 offset:56320
    v_exp_f32 v20, v20
    v_exp_f32 v21, v21
    v_exp_f32 v22, v22
    v_exp_f32 v23, v23
    v_exp_f32 v24, v24
    v_exp_f32 v25, v25
    s_waitcnt lgkmcnt(1)
    v_smfmac_f32_32x32x32_bf16 v[64:79], v[88:91], v[16:23], v100
    s_mov_b64 exec, s[64:65]
    ds_read_b128 v[88:91], v102 offset:55296
    ds_read_b128 v[96:99], v102 offset:55808
    s_mov_b64 exec, -1
    v_exp_f32 v26, v26
    v_exp_f32 v27, v27
    v_exp_f32 v28, v28
    s_add_u32 m0, s66, 155648
    s_mov_b32 s6, 458752
    buffer_load_dwordx4 v184, s[52:55], s6 offen lds
    v_exp_f32 v29, v29
    v_exp_f32 v30, v30
    v_exp_f32 v31, v31
    s_setprio 0
    v_exp_f32 v32, v32
    v_exp_f32 v33, v33
    v_smfmac_f32_32x32x32_bf16 v[64:79], v[92:95], v[24:31], v100
    v_exp_f32 v34, v34
    v_exp_f32 v35, v35
    s_waitcnt lgkmcnt(2)
    v_mfma_f32_32x32x16_bf16 v[16:31], v[80:83], v[84:87], v[48:63]
    ds_read_b128 v[80:83], v180 offset:57344
    v_exp_f32 v36, v36
    v_exp_f32 v37, v37
    v_exp_f32 v38, v38
    v_exp_f32 v39, v39
    v_exp_f32 v40, v40
    v_exp_f32 v41, v41
    s_waitcnt lgkmcnt(1)
    v_smfmac_f32_32x32x32_bf16 v[64:79], v[88:91], v[32:39], v100
    s_mov_b64 exec, s[64:65]
    ds_read_b128 v[88:91], v102 offset:56320
    ds_read_b128 v[92:95], v102 offset:56832
    s_mov_b64 exec, -1
    v_exp_f32 v42, v42
    v_exp_f32 v43, v43
    v_exp_f32 v44, v44
    s_add_u32 m0, s66, 131072
    s_mov_b32 s6, 393216
    buffer_load_dwordx4 v184, s[48:51], s6 offen lds
    s_lshr_b32 s6, s5, 3
    s_lshl_b32 s79, s4, 2
    s_add_u32 s79, s79, s6
    s_lshl_b32 s80, s79, 1
    s_and_b32 s6, s3, 1
    s_add_u32 s80, s80, s6
    s_lshl_b32 s82, s80, 12
    s_add_u32 s82, s82, 17039360
    s_lshl_b32 s83, s80, 15
    s_lshr_b32 s6, s3, 1
    s_lshl_b32 s6, s6, 13
    s_add_u32 s83, s83, s6
    s_add_u32 s83, s83, 12582912
    s_add_u32 s84, s83, 4096
    s_add_u32 s80, s83, 2097152
    s_add_u32 s75, s84, 2097152
    buffer_load_dwordx2 v[8:9], v195, s[8:11], s82 offen sc1
    v_exp_f32 v45, v45
    v_exp_f32 v46, v46
    v_exp_f32 v47, v47
    s_setprio 3
    v_exp_f32 v16, v16
    v_exp_f32 v17, v17
    v_smfmac_f32_32x32x32_bf16 v[64:79], v[96:99], v[40:47], v100
    v_exp_f32 v18, v18
    v_exp_f32 v19, v19
    s_waitcnt lgkmcnt(2)
    v_mfma_f32_32x32x16_bf16 v[32:47], v[80:83], v[84:87], v[48:63]
    ds_read_b128 v[80:83], v180 offset:58368
    v_exp_f32 v20, v20
    v_exp_f32 v21, v21
    v_exp_f32 v22, v22
    v_exp_f32 v23, v23
    v_exp_f32 v24, v24
    v_exp_f32 v25, v25
    s_waitcnt lgkmcnt(1)
    v_smfmac_f32_32x32x32_bf16 v[64:79], v[88:91], v[16:23], v100
    s_mov_b64 exec, s[64:65]
    ds_read_b128 v[88:91], v102 offset:57344
    ds_read_b128 v[96:99], v102 offset:57856
    s_mov_b64 exec, -1
    v_exp_f32 v26, v26
    v_exp_f32 v27, v27
    v_exp_f32 v28, v28
    s_add_u32 m0, s66, 139264
    s_mov_b32 s6, 458752
    buffer_load_dwordx4 v184, s[48:51], s6 offen lds
    v_exp_f32 v29, v29
    v_exp_f32 v30, v30
    v_exp_f32 v31, v31
    s_setprio 2
    v_exp_f32 v32, v32
    v_exp_f32 v33, v33
    v_smfmac_f32_32x32x32_bf16 v[64:79], v[92:95], v[24:31], v100
    v_exp_f32 v34, v34
    v_exp_f32 v35, v35
    s_waitcnt lgkmcnt(2)
    v_mfma_f32_32x32x16_bf16 v[16:31], v[80:83], v[84:87], v[48:63]
    ds_read_b128 v[80:83], v180 offset:59392
    v_exp_f32 v36, v36
    v_exp_f32 v37, v37
    v_exp_f32 v38, v38
    v_exp_f32 v39, v39
    v_exp_f32 v40, v40
    v_exp_f32 v41, v41
    s_waitcnt lgkmcnt(1)
    v_smfmac_f32_32x32x32_bf16 v[64:79], v[88:91], v[32:39], v100
    s_mov_b64 exec, s[64:65]
    ds_read_b128 v[88:91], v102 offset:58368
    ds_read_b128 v[92:95], v102 offset:58880
    s_mov_b64 exec, -1
    v_exp_f32 v42, v42
    v_exp_f32 v43, v43
    v_exp_f32 v44, v44
    v_exp_f32 v45, v45
    v_exp_f32 v46, v46
    v_exp_f32 v47, v47
    s_setprio 1
    v_exp_f32 v16, v16
    v_exp_f32 v17, v17
    v_smfmac_f32_32x32x32_bf16 v[64:79], v[96:99], v[40:47], v100
    v_exp_f32 v18, v18
    v_exp_f32 v19, v19
    s_waitcnt lgkmcnt(2)
    v_mfma_f32_32x32x16_bf16 v[32:47], v[80:83], v[84:87], v[48:63]
    ds_read_b128 v[80:83], v180 offset:60416
    v_exp_f32 v20, v20
    v_exp_f32 v21, v21
    v_exp_f32 v22, v22
    v_exp_f32 v23, v23
    v_exp_f32 v24, v24
    v_exp_f32 v25, v25
    s_waitcnt lgkmcnt(1)
    v_smfmac_f32_32x32x32_bf16 v[64:79], v[88:91], v[16:23], v100
    s_mov_b64 exec, s[64:65]
    ds_read_b128 v[88:91], v102 offset:59392
    ds_read_b128 v[96:99], v102 offset:59904
    s_mov_b64 exec, -1
    v_exp_f32 v26, v26
    v_exp_f32 v27, v27
    v_exp_f32 v28, v28
    s_waitcnt vmcnt(1)
    v_cmp_ne_u32 vcc, s85, v8
    s_nop 1
    s_or_b32 s81, vcc_lo, vcc_hi
    s_cmp_lg_u32 s81, 0
    s_cbranch_scc1 L_nob0
    buffer_load_dwordx4 v[196:199], v180, s[8:11], s80 offen offset:0 sc1
    buffer_load_dwordx4 v[200:203], v180, s[8:11], s80 offen offset:1024 sc1
L_nob0:
    v_exp_f32 v29, v29
    v_exp_f32 v30, v30
    v_exp_f32 v31, v31
    s_setprio 0
    v_exp_f32 v32, v32
    v_exp_f32 v33, v33
    v_smfmac_f32_32x32x32_bf16 v[64:79], v[92:95], v[24:31], v100
    v_exp_f32 v34, v34
    v_exp_f32 v35, v35
    s_waitcnt lgkmcnt(2)
    v_mfma_f32_32x32x16_bf16 v[16:31], v[80:83], v[84:87], v[48:63]
    ds_read_b128 v[80:83], v180 offset:61440
    v_exp_f32 v36, v36
    v_exp_f32 v37, v37
    v_exp_f32 v38, v38
    v_exp_f32 v39, v39
    v_exp_f32 v40, v40
    v_exp_f32 v41, v41
    s_waitcnt lgkmcnt(1)
    v_smfmac_f32_32x32x32_bf16 v[64:79], v[88:91], v[32:39], v100
    s_mov_b64 exec, s[64:65]
    ds_read_b128 v[88:91], v102 offset:60416
    ds_read_b128 v[92:95], v102 offset:60928
    s_mov_b64 exec, -1
    v_exp_f32 v42, v42
    v_exp_f32 v43, v43
    v_exp_f32 v44, v44
    s_cmp_lg_u32 s81, 0
    s_cbranch_scc1 L_nob1
    buffer_load_dwordx4 v[204:207], v180, s[8:11], s80 offen offset:2048 sc1
    buffer_load_dwordx4 v[208:211], v180, s[8:11], s80 offen offset:3072 sc1
L_nob1:
    v_exp_f32 v45, v45
    v_exp_f32 v46, v46
    v_exp_f32 v47, v47
    s_setprio 3
    v_exp_f32 v16, v16
    v_exp_f32 v17, v17
    v_smfmac_f32_32x32x32_bf16 v[64:79], v[96:99], v[40:47], v100
    v_exp_f32 v18, v18
    v_exp_f32 v19, v19
    s_waitcnt lgkmcnt(2)
    v_mfma_f32_32x32x16_bf16 v[32:47], v[80:83], v[84:87], v[48:63]
    ds_read_b128 v[80:83], v180 offset:62464
    v_exp_f32 v20, v20
    v_exp_f32 v21, v21
    v_exp_f32 v22, v22
    v_exp_f32 v23, v23
    v_exp_f32 v24, v24
    v_exp_f32 v25, v25
    s_waitcnt lgkmcnt(1)
    v_smfmac_f32_32x32x32_bf16 v[64:79], v[88:91], v[16:23], v100
    s_mov_b64 exec, s[64:65]
    ds_read_b128 v[88:91], v102 offset:61440
    ds_read_b128 v[96:99], v102 offset:61952
    s_mov_b64 exec, -1
    v_exp_f32 v26, v26
    v_exp_f32 v27, v27
    v_exp_f32 v28, v28
    s_cmp_lg_u32 s81, 0
    s_cbranch_scc1 L_nob2
    buffer_load_dwordx4 v[212:215], v180, s[8:11], s75 offen offset:0 sc1
    buffer_load_dwordx4 v[216:219], v180, s[8:11], s75 offen offset:1024 sc1
L_nob2:
    v_exp_f32 v29, v29
    v_exp_f32 v30, v30
    v_exp_f32 v31, v31
    s_setprio 2
    v_exp_f32 v32, v32
    v_exp_f32 v33, v33
    v_smfmac_f32_32x32x32_bf16 v[64:79], v[92:95], v[24:31], v100
    v_exp_f32 v34, v34
    v_exp_f32 v35, v35
    s_waitcnt lgkmcnt(2)
    v_mfma_f32_32x32x16_bf16 v[16:31], v[80:83], v[84:87], v[48:63]
    ds_read_b128 v[80:83], v180 offset:63488
    v_exp_f32 v36, v36
    v_exp_f32 v37, v37
    v_exp_f32 v38, v38
    v_exp_f32 v39, v39
    v_exp_f32 v40, v40
    v_exp_f32 v41, v41
    s_waitcnt lgkmcnt(1)
    v_smfmac_f32_32x32x32_bf16 v[64:79], v[88:91], v[32:39], v100
    s_mov_b64 exec, s[64:65]
    ds_read_b128 v[88:91], v102 offset:62464
    ds_read_b128 v[92:95], v102 offset:62976
    s_mov_b64 exec, -1
    v_exp_f32 v42, v42
    v_exp_f32 v43, v43
    v_exp_f32 v44, v44
    s_cmp_lg_u32 s81, 0
    s_cbranch_scc1 L_nob3
    buffer_load_dwordx4 v[220:223], v180, s[8:11], s75 offen offset:2048 sc1
    buffer_load_dwordx4 v[224:227], v180, s[8:11], s75 offen offset:3072 sc1
L_nob3:
    v_exp_f32 v45, v45
    v_exp_f32 v46, v46
    v_exp_f32 v47, v47
    s_setprio 1
    v_exp_f32 v16, v16
    v_exp_f32 v17, v17
    v_smfmac_f32_32x32x32_bf16 v[64:79], v[96:99], v[40:47], v100
    v_exp_f32 v18, v18
    v_exp_f32 v19, v19
    s_waitcnt lgkmcnt(2)
    v_mfma_f32_32x32x16_bf16 v[32:47], v[80:83], v[84:87], v[48:63]
    ds_read_b128 v[80:83], v180 offset:64512
    v_exp_f32 v20, v20
    v_exp_f32 v21, v21
    v_exp_f32 v22, v22
    v_exp_f32 v23, v23
    v_exp_f32 v24, v24
    v_exp_f32 v25, v25
    s_waitcnt lgkmcnt(1)
    v_smfmac_f32_32x32x32_bf16 v[64:79], v[88:91], v[16:23], v100
    s_mov_b64 exec, s[64:65]
    ds_read_b128 v[88:91], v102 offset:63488
    ds_read_b128 v[96:99], v102 offset:64000
    s_mov_b64 exec, -1
    v_exp_f32 v26, v26
    v_exp_f32 v27, v27
    v_exp_f32 v28, v28
    v_exp_f32 v29, v29
    v_exp_f32 v30, v30
    v_exp_f32 v31, v31
    s_setprio 0
    v_exp_f32 v32, v32
    v_exp_f32 v33, v33
    v_smfmac_f32_32x32x32_bf16 v[64:79], v[92:95], v[24:31], v100
    v_exp_f32 v34, v34
    v_exp_f32 v35, v35
    s_waitcnt lgkmcnt(2)
    v_mfma_f32_32x32x16_bf16 v[16:31], v[80:83], v[84:87], v[48:63]
    v_exp_f32 v36, v36
    v_exp_f32 v37, v37
    v_exp_f32 v38, v38
    v_exp_f32 v39, v39
    v_exp_f32 v40, v40
    v_exp_f32 v41, v41
    s_waitcnt lgkmcnt(0)
    v_smfmac_f32_32x32x32_bf16 v[64:79], v[88:91], v[32:39], v100
    s_mov_b64 exec, s[64:65]
    ds_read_b128 v[88:91], v102 offset:64512
    ds_read_b128 v[92:95], v102 offset:65024
    s_mov_b64 exec, -1
    v_exp_f32 v42, v42
    v_exp_f32 v43, v43
    v_exp_f32 v44, v44
    v_exp_f32 v45, v45
    v_exp_f32 v46, v46
    v_exp_f32 v47, v47
    s_setprio 3
    v_exp_f32 v16, v16
    v_exp_f32 v17, v17
    v_smfmac_f32_32x32x32_bf16 v[64:79], v[96:99], v[40:47], v100
    v_exp_f32 v18, v18
    v_exp_f32 v19, v19
    v_exp_f32 v20, v20
    v_exp_f32 v21, v21
    v_exp_f32 v22, v22
    v_exp_f32 v23, v23
    v_exp_f32 v24, v24
    v_exp_f32 v25, v25
    s_waitcnt lgkmcnt(0)
    v_smfmac_f32_32x32x32_bf16 v[64:79], v[88:91], v[16:23], v100
    v_exp_f32 v26, v26
    v_exp_f32 v27, v27
    v_exp_f32 v28, v28
    v_exp_f32 v29, v29
    v_exp_f32 v30, v30
    v_exp_f32 v31, v31
    s_nop 1
    v_smfmac_f32_32x32x32_bf16 v[64:79], v[92:95], v[24:31], v100
    s_setprio 0
    s_nop 10
    v_rcp_f32 v106, v72
    v_max3_f32 v104, abs(v64), abs(v65), abs(v66)
    v_max3_f32 v105, abs(v67), abs(v68), abs(v69)
    v_cmp_gt_f32 vcc, 0x5f800000, v72
    v_max3_f32 v104, v104, abs(v70), abs(v71)
    s_mov_b32 s7, 0x7f800000
    v_max_f32 v104, v104, v105
    v_cmp_gt_f32 s[72:73], s7, v104
L_ok_A:
    v_mul_f32 v106, v106, v11
    v_pk_mul_f32 v[64:65], v[64:65], v[106:107] op_sel_hi:[1,0]
    v_pk_mul_f32 v[66:67], v[66:67], v[106:107] op_sel_hi:[1,0]
    v_pk_mul_f32 v[68:69], v[68:69], v[106:107] op_sel_hi:[1,0]
    v_pk_mul_f32 v[70:71], v[70:71], v[106:107] op_sel_hi:[1,0]
    s_and_b64 s[72:73], s[72:73], vcc
    v_cvt_pk_bf16_f32 v72, v64, v65
    v_cvt_pk_bf16_f32 v73, v66, v67
    v_cvt_pk_bf16_f32 v74, v68, v69
    v_cvt_pk_bf16_f32 v75, v70, v71
    s_cmp_eq_u64 s[72:73], -1
    v_min_u32 v72, -2, v72
    v_min_u32 v73, -2, v73
    v_min_u32 v74, -2, v74
    v_min_u32 v75, -2, v75
    s_cbranch_scc0 L_fb_A
    buffer_store_dwordx4 v[72:75], v180, s[8:11], s78 offen sc1
    v_lshrrev_b32 v5, 5, v1
    v_bfe_u32 v6, v1, 2, 2
    v_lshl_add_u32 v7, v5, 2, v6
    v_lshlrev_b32 v7, 7, v7
    v_lshrrev_b32 v6, 1, v6
    v_lshl_add_u32 v7, v6, 6, v7
    v_bfe_u32 v6, v1, 4, 1
    v_lshl_add_u32 v7, v6, 5, v7
    v_and_b32 v6, 3, v1
    v_lshl_add_u32 v7, v6, 3, v7
    s_lshr_b32 s73, s3, 1
    s_lshl_b32 s6, s73, 14
    s_mov_b32 s72, 0x10000
    s_cmp_eq_u32 s73, 3
    s_cselect_b32 s6, 131072, s6
    s_cselect_b32 s72, 0x4000, s72
    v_add_u32 v185, s6, v7
    v_xor_b32 v186, 64, v185
    v_add_u32 v187, s72, v185
    v_add_u32 v188, s72, v186
    s_cmp_lg_u32 s81, 0
    s_cbranch_scc1 L_ob_late
    s_waitcnt vmcnt(1)
L_ob_join:
    s_barrier
    s_or_b32 s6, s2, s3
    s_cmp_lg_u32 s6, 0
    s_cbranch_scc1 L_noepoch
    s_mov_b32 s6, 16842752
    v_mov_b32 v16, s85
    v_mov_b32 v17, s60
    v_mov_b32 v18, s85
    v_mov_b32 v19, s60
    s_mov_b64 exec, 0xff
    buffer_store_dwordx4 v[16:19], v180, s[8:11], s6 offen sc1
    s_mov_b64 exec, -1
L_noepoch:
    ds_read_b64_tr_b16 v[32:33], v187 offset:0
    ds_read_b64_tr_b16 v[34:35], v187 offset:1024
    ds_read_b64_tr_b16 v[36:37], v188 offset:0
    ds_read_b64_tr_b16 v[38:39], v188 offset:1024
    s_mov_b32 s7, 0x40000
    ds_read_b64_tr_b16 v[40:41], v187 offset:2048
    ds_read_b64_tr_b16 v[42:43], v187 offset:3072
    ds_read_b64_tr_b16 v[44:45], v188 offset:2048
    ds_read_b64_tr_b16 v[46:47], v188 offset:3072
    s_waitcnt lgkmcnt(4)
    v_mfma_f32_32x32x16_bf16 v[96:111], v[196:199], v[32:35], 0
    v_mfma_f32_32x32x16_bf16 v[112:127], v[196:199], v[36:39], 0
    ds_read_b64_tr_b16 v[32:33], v187 offset:4096
    ds_read_b64_tr_b16 v[34:35], v187 offset:5120
    ds_read_b64_tr_b16 v[36:37], v188 offset:4096
    ds_read_b64_tr_b16 v[38:39], v188 offset:5120
    s_waitcnt lgkmcnt(4)
    v_mfma_f32_32x32x16_bf16 v[96:111], v[200:203], v[40:43], v[96:111]
    v_mfma_f32_32x32x16_bf16 v[112:127], v[200:203], v[44:47], v[112:127]
    ds_read_b64_tr_b16 v[40:41], v187 offset:6144
    ds_read_b64_tr_b16 v[42:43], v187 offset:7168
    ds_read_b64_tr_b16 v[44:45], v188 offset:6144
    ds_read_b64_tr_b16 v[46:47], v188 offset:7168
    s_waitcnt lgkmcnt(4)
    v_mfma_f32_32x32x16_bf16 v[96:111], v[204:207], v[32:35], v[96:111]
    v_mfma_f32_32x32x16_bf16 v[112:127], v[204:207], v[36:39], v[112:127]
    ds_read_b64_tr_b16 v[32:33], v187 offset:8192
    ds_read_b64_tr_b16 v[34:35], v187 offset:9216
    ds_read_b64_tr_b16 v[36:37], v188 offset:8192
    ds_read_b64_tr_b16 v[38:39], v188 offset:9216
    s_waitcnt lgkmcnt(4)
    v_mfma_f32_32x32x16_bf16 v[96:111], v[208:211], v[40:43], v[96:111]
    v_mfma_f32_32x32x16_bf16 v[112:127], v[208:211], v[44:47], v[112:127]
    ds_read_b64_tr_b16 v[40:41], v187 offset:10240
    ds_read_b64_tr_b16 v[42:43], v187 offset:11264
    ds_read_b64_tr_b16 v[44:45], v188 offset:10240
    ds_read_b64_tr_b16 v[46:47], v188 offset:11264
    s_waitcnt lgkmcnt(4)
    v_mfma_f32_32x32x16_bf16 v[96:111], v[212:215], v[32:35], v[96:111]
    v_mfma_f32_32x32x16_bf16 v[112:127], v[212:215], v[36:39], v[112:127]
    buffer_load_dwordx4 v[128:131], v180, s[8:11], s83 offen offset:0 sc1
    buffer_load_dwordx4 v[132:135], v180, s[8:11], s83 offen offset:1024 sc1
    ds_read_b64_tr_b16 v[32:33], v187 offset:12288
    ds_read_b64_tr_b16 v[34:35], v187 offset:13312
    ds_read_b64_tr_b16 v[36:37], v188 offset:12288
    ds_read_b64_tr_b16 v[38:39], v188 offset:13312
    s_waitcnt lgkmcnt(4)
    v_mfma_f32_32x32x16_bf16 v[96:111], v[216:219], v[40:43], v[96:111]
    v_mfma_f32_32x32x16_bf16 v[112:127], v[216:219], v[44:47], v[112:127]
    buffer_load_dwordx4 v[136:139], v180, s[8:11], s83 offen offset:2048 sc1
    buffer_load_dwordx4 v[140:143], v180, s[8:11], s83 offen offset:3072 sc1
    ds_read_b64_tr_b16 v[40:41], v187 offset:14336
    ds_read_b64_tr_b16 v[42:43], v187 offset:15360
    ds_read_b64_tr_b16 v[44:45], v188 offset:14336
    ds_read_b64_tr_b16 v[46:47], v188 offset:15360
    s_waitcnt lgkmcnt(4)
    v_mfma_f32_32x32x16_bf16 v[96:111], v[220:223], v[32:35], v[96:111]
    v_mfma_f32_32x32x16_bf16 v[112:127], v[220:223], v[36:39], v[112:127]
    buffer_load_dwordx4 v[144:147], v180, s[8:11], s84 offen offset:0 sc1
    buffer_load_dwordx4 v[148:151], v180, s[8:11], s84 offen offset:1024 sc1
    ds_read_b64_tr_b16 v[32:33], v185 offset:0
    ds_read_b64_tr_b16 v[34:35], v185 offset:1024
    ds_read_b64_tr_b16 v[36:37], v186 offset:0
    ds_read_b64_tr_b16 v[38:39], v186 offset:1024
    s_waitcnt lgkmcnt(4)
    v_mfma_f32_32x32x16_bf16 v[96:111], v[224:227], v[40:43], v[96:111]
    v_mfma_f32_32x32x16_bf16 v[112:127], v[224:227], v[44:47], v[112:127]
    buffer_load_dwordx4 v[152:155], v180, s[8:11], s84 offen offset:2048 sc1
    buffer_load_dwordx4 v[156:159], v180, s[8:11], s84 offen offset:3072 sc1
    v_lshrrev_b32 v6, 3, v0
    v_and_b32 v7, 7, v0
    v_and_b32 v4, 3, v6
    v_bfe_u32 v5, v6, 3, 2
    v_lshl_add_u32 v190, v5, 2, v4
    v_lshlrev_b32 v190, 8, v190
    v_lshrrev_b32 v4, 1, v4
    v_cmp_eq_u32 s[74:75], 1, v4
    v_lshl_add_u32 v190, v4, 4, v190
    v_bfe_u32 v4, v6, 2, 1
    v_lshl_add_u32 v190, v4, 7, v190
    v_and_b32 v4, 3, v7
    v_lshl_add_u32 v190, v4, 5, v190
    v_lshrrev_b32 v4, 2, v7
    v_mul_u32_u24 v4, 4224, v4
    s_lshr_b32 s6, s3, 2
    s_mul_i32 s6, s6, 8448
    s_add_u32 s6, s6, 49152
    v_add3_u32 v190, v190, v4, s6
    v_xor_b32 v191, 16, v190
    s_and_b32 s6, s5, 7
    s_lshl_b32 s6, s6, 7
    v_lshlrev_b32 v192, 10, v6
    v_lshl_add_u32 v192, v7, 4, v192
    v_add_u32 v192, s6, v192
    s_mul_i32 s6, s3, 8448
    s_add_u32 m0, s6, 0
    s_barrier
L_o_chk00:
    s_waitcnt vmcnt(7)
    v_max3_u32 v14, v128, v129, v130
    v_max_u32 v14, v14, v131
    v_cmp_eq_u32 vcc, -1, v14
    s_cbranch_vccnz L_o_re00
L_o_go00:
    ds_read_b64_tr_b16 v[40:41], v185 offset:2048
    ds_read_b64_tr_b16 v[42:43], v185 offset:3072
    ds_read_b64_tr_b16 v[44:45], v186 offset:2048
    ds_read_b64_tr_b16 v[46:47], v186 offset:3072
    s_waitcnt lgkmcnt(4)
    v_mfma_f32_32x32x16_bf16 v[96:111], v[128:131], v[32:35], v[96:111]
    v_mfma_f32_32x32x16_bf16 v[112:127], v[128:131], v[36:39], v[112:127]
L_o_chk01:
    s_waitcnt vmcnt(6)
    v_max3_u32 v14, v132, v133, v134
    v_max_u32 v14, v14, v135
    v_cmp_eq_u32 vcc, -1, v14
    s_cbranch_vccnz L_o_re01
L_o_go01:
    ds_read_b64_tr_b16 v[32:33], v185 offset:4096
    ds_read_b64_tr_b16 v[34:35], v185 offset:5120
    ds_read_b64_tr_b16 v[36:37], v186 offset:4096
    ds_read_b64_tr_b16 v[38:39], v186 offset:5120
    s_waitcnt lgkmcnt(4)
    v_mfma_f32_32x32x16_bf16 v[96:111], v[132:135], v[40:43], v[96:111]
    v_mfma_f32_32x32x16_bf16 v[112:127], v[132:135], v[44:47], v[112:127]
L_o_chk02:
    s_waitcnt vmcnt(5)
    v_max3_u32 v14, v136, v137, v138
    v_max_u32 v14, v14, v139
    v_cmp_eq_u32 vcc, -1, v14
    s_cbranch_vccnz L_o_re02
L_o_go02:
    ds_read_b64_tr_b16 v[40:41], v185 offset:6144
    ds_read_b64_tr_b16 v[42:43], v185 offset:7168
    ds_read_b64_tr_b16 v[44:45], v186 offset:6144
    ds_read_b64_tr_b16 v[46:47], v186 offset:7168
    s_waitcnt lgkmcnt(4)
    v_mfma_f32_32x32x16_bf16 v[96:111], v[136:139], v[32:35], v[96:111]
    v_mfma_f32_32x32x16_bf16 v[112:127], v[136:139], v[36:39], v[112:127]
L_o_chk03:
    s_waitcnt vmcnt(4)
    v_max3_u32 v14, v140, v141, v142
    v_max_u32 v14, v14, v143
    v_cmp_eq_u32 vcc, -1, v14
    s_cbranch_vccnz L_o_re03
L_o_go03:
    ds_read_b64_tr_b16 v[32:33], v185 offset:8192
    ds_read_b64_tr_b16 v[34:35], v185 offset:9216
    ds_read_b64_tr_b16 v[36:37], v186 offset:8192
    ds_read_b64_tr_b16 v[38:39], v186 offset:9216
    s_waitcnt lgkmcnt(4)
    v_mfma_f32_32x32x16_bf16 v[96:111], v[140:143], v[40:43], v[96:111]
    v_mfma_f32_32x32x16_bf16 v[112:127], v[140:143], v[44:47], v[112:127]
L_o_chk04:
    s_waitcnt vmcnt(3)
    v_max3_u32 v14, v144, v145, v146
    v_max_u32 v14, v14, v147
    v_cmp_eq_u32 vcc, -1, v14
    s_cbranch_vccnz L_o_re04
L_o_go04:
    ds_read_b64_tr_b16 v[40:41], v185 offset:10240
    ds_read_b64_tr_b16 v[42:43], v185 offset:11264
    ds_read_b64_tr_b16 v[44:45], v186 offset:10240
    ds_read_b64_tr_b16 v[46:47], v186 offset:11264
    s_waitcnt lgkmcnt(4)
    v_mfma_f32_32x32x16_bf16 v[96:111], v[144:147], v[32:35], v[96:111]
    v_mfma_f32_32x32x16_bf16 v[112:127], v[144:147], v[36:39], v[112:127]
L_o_chk05:
    s_waitcnt vmcnt(2)
    v_max3_u32 v14, v148, v149, v150
    v_max_u32 v14, v14, v151
    v_cmp_eq_u32 vcc, -1, v14
    s_cbranch_vccnz L_o_re05
L_o_go05:
    ds_read_b64_tr_b16 v[32:33], v185 offset:12288
    ds_read_b64_tr_b16 v[34:35], v185 offset:13312
    ds_read_b64_tr_b16 v[36:37], v186 offset:12288
    ds_read_b64_tr_b16 v[38:39], v186 offset:13312
    s_waitcnt lgkmcnt(4)
    v_mfma_f32_32x32x16_bf16 v[96:111], v[148:151], v[40:43], v[96:111]
    v_mfma_f32_32x32x16_bf16 v[112:127], v[148:151], v[44:47], v[112:127]
L_o_chk06:
    s_waitcnt vmcnt(1)
    v_max3_u32 v14, v152, v153, v154
    v_max_u32 v14, v14, v155
    v_cmp_eq_u32 vcc, -1, v14
    s_cbranch_vccnz L_o_re06
L_o_go06:
    ds_read_b64_tr_b16 v[40:41], v185 offset:14336
    ds_read_b64_tr_b16 v[42:43], v185 offset:15360
    ds_read_b64_tr_b16 v[44:45], v186 offset:14336
    ds_read_b64_tr_b16 v[46:47], v186 offset:15360
    s_waitcnt lgkmcnt(4)
    v_mfma_f32_32x32x16_bf16 v[96:111], v[152:155], v[32:35], v[96:111]
    v_mfma_f32_32x32x16_bf16 v[112:127], v[152:155], v[36:39], v[112:127]
L_o_chk07:
    s_waitcnt vmcnt(0)
    v_max3_u32 v14, v156, v157, v158
    v_max_u32 v14, v14, v159
    v_cmp_eq_u32 vcc, -1, v14
    s_cbranch_vccnz L_o_re07
L_o_go07:
    s_waitcnt lgkmcnt(0)
    v_mfma_f32_32x32x16_bf16 v[96:111], v[156:159], v[40:43], v[96:111]
    v_mfma_f32_32x32x16_bf16 v[112:127], v[156:159], v[44:47], v[112:127]
    s_nop 10
    ds_write_addtid_b32 v96 offset:49152
    ds_write_addtid_b32 v97 offset:49408
    ds_write_addtid_b32 v98 offset:49664
    ds_write_addtid_b32 v99 offset:49920
    ds_write_addtid_b32 v100 offset:50176
    ds_write_addtid_b32 v101 offset:50432
    ds_write_addtid_b32 v102 offset:50688
    ds_write_addtid_b32 v103 offset:50944
    ds_write_addtid_b32 v104 offset:51200
    ds_write_addtid_b32 v105 offset:51456
    ds_write_addtid_b32 v106 offset:51712
    ds_write_addtid_b32 v107 offset:51968
    ds_write_addtid_b32 v108 offset:52224
    ds_write_addtid_b32 v109 offset:52480
    ds_write_addtid_b32 v110 offset:52736
    ds_write_addtid_b32 v111 offset:52992
    ds_write_addtid_b32 v112 offset:53376
    ds_write_addtid_b32 v113 offset:53632
    ds_write_addtid_b32 v114 offset:53888
    ds_write_addtid_b32 v115 offset:54144
    ds_write_addtid_b32 v116 offset:54400
    ds_write_addtid_b32 v117 offset:54656
    ds_write_addtid_b32 v118 offset:54912
    ds_write_addtid_b32 v119 offset:55168
    ds_write_addtid_b32 v120 offset:55424
    ds_write_addtid_b32 v121 offset:55680
    ds_write_addtid_b32 v122 offset:55936
    ds_write_addtid_b32 v123 offset:56192
    ds_write_addtid_b32 v124 offset:56448
    ds_write_addtid_b32 v125 offset:56704
    ds_write_addtid_b32 v126 offset:56960
    ds_write_addtid_b32 v127 offset:57216
    s_lshl_b32 s79, s79, 16
    s_waitcnt lgkmcnt(0)
    s_barrier
    ds_read_b128 v[32:35], v190 offset:0
    ds_read_b128 v[36:39], v191 offset:0
    ds_read_b128 v[40:43], v190 offset:16896
    ds_read_b128 v[44:47], v191 offset:16896
    ds_read_b128 v[48:51], v190 offset:33792
    ds_read_b128 v[52:55], v191 offset:33792
    ds_read_b128 v[56:59], v190 offset:50688
    ds_read_b128 v[60:63], v191 offset:50688
    s_waitcnt lgkmcnt(4)
    v_pk_add_f32 v[32:33], v[32:33], v[40:41]
    v_pk_add_f32 v[34:35], v[34:35], v[42:43]
    v_pk_add_f32 v[36:37], v[36:37], v[44:45]
    v_pk_add_f32 v[38:39], v[38:39], v[46:47]
    s_waitcnt lgkmcnt(0)
    v_pk_add_f32 v[48:49], v[48:49], v[56:57]
    v_pk_add_f32 v[50:51], v[50:51], v[58:59]
    v_pk_add_f32 v[52:53], v[52:53], v[60:61]
    v_pk_add_f32 v[54:55], v[54:55], v[62:63]
    v_pk_add_f32 v[32:33], v[32:33], v[48:49]
    v_pk_add_f32 v[34:35], v[34:35], v[50:51]
    v_pk_add_f32 v[36:37], v[36:37], v[52:53]
    v_pk_add_f32 v[38:39], v[38:39], v[54:55]
    v_cvt_pk_bf16_f32 v20, v32, v33
    v_cvt_pk_bf16_f32 v21, v34, v35
    v_cvt_pk_bf16_f32 v22, v36, v37
    v_cvt_pk_bf16_f32 v23, v38, v39
    v_cndmask_b32_e64 v16, v20, v22, s[74:75]
    v_cndmask_b32_e64 v17, v21, v23, s[74:75]
    v_cndmask_b32_e64 v18, v22, v20, s[74:75]
    v_cndmask_b32_e64 v19, v23, v21, s[74:75]
    buffer_store_dwordx4 v[16:19], v192, s[56:59], s79 offen nt
L_end:
    s_endpgm
L_fb_spin:
    s_lshl_b32 s6, s4, 13
    s_add_u32 s6, s6, 16973824
    s_mov_b32 s7, 0x40000
    buffer_load_dword v8, v195, s[8:11], s6 offen sc1
    s_sleep 4
    buffer_load_dword v9, v195, s[8:11], s6 offen sc1
L_poll_fb:
    s_waitcnt vmcnt(1)
    v_cmp_ne_u32 vcc, s85, v8
    s_cbranch_vccz L_pdone_fb
    buffer_load_dword v8, v195, s[8:11], s6 offen sc1
    s_waitcnt vmcnt(1)
    v_cmp_ne_u32 vcc, s85, v9
    s_cbranch_vccz L_pdone_fb
    buffer_load_dword v9, v195, s[8:11], s6 offen sc1
    s_sub_u32 s7, s7, 1
    s_cmp_lg_u32 s7, 0
    s_cbranch_scc1 L_poll_fb
L_pdone_fb:
    s_branch L_fb_go
L_g_spin:
    s_lshl_b32 s6, s68, 3
    s_add_u32 s6, s6, s3
    s_lshl_b32 s6, s6, 12
    s_add_u32 s6, s6, 17301504
    s_mov_b32 s7, 0x40000
L_g_poll:
    buffer_load_dwordx2 v[10:11], v195, s[8:11], s6 offen sc1
    s_waitcnt vmcnt(0)
    v_cmp_ne_u32 vcc, s85, v10
    s_cbranch_vccz L_g_go
    s_sleep 4
    s_sub_u32 s7, s7, 1
    s_cbranch_scc0 L_g_poll
    s_branch L_g_go
L_B_k0:
    s_call_b64 s[76:77], L_B_kill
    s_branch L_B_sk0
L_B_k1:
    s_call_b64 s[76:77], L_B_kill
    s_branch L_B_sk1
L_B_k2:
    s_call_b64 s[76:77], L_B_kill
    s_branch L_B_sk2
L_B_k3:
    s_call_b64 s[76:77], L_B_kill
    s_branch L_B_sk3
L_B_k4:
    s_call_b64 s[76:77], L_B_kill
    s_branch L_B_sk4
L_B_k5:
    s_call_b64 s[76:77], L_B_kill
    s_branch L_B_sk5
L_B_k6:
    s_call_b64 s[76:77], L_B_kill
    s_branch L_B_sk6
L_B_k7:
    s_call_b64 s[76:77], L_B_kill
    s_branch L_B_sk7
L_B_kill:
    v_mov_b32 v104, 4286578688
    v_mov_b32 v105, 4286578688
    v_pk_mov_b32 v[160:161], v[104:105], v[104:105]
    v_pk_mov_b32 v[162:163], v[104:105], v[104:105]
    v_pk_mov_b32 v[164:165], v[104:105], v[104:105]
    v_pk_mov_b32 v[166:167], v[104:105], v[104:105]
    v_pk_mov_b32 v[168:169], v[104:105], v[104:105]
    v_pk_mov_b32 v[170:171], v[104:105], v[104:105]
    v_pk_mov_b32 v[172:173], v[104:105], v[104:105]
    v_pk_mov_b32 v[174:175], v[104:105], v[104:105]
    v_pk_mov_b32 v[144:145], v[104:105], v[104:105]
    v_pk_mov_b32 v[146:147], v[104:105], v[104:105]
    v_pk_mov_b32 v[148:149], v[104:105], v[104:105]
    v_pk_mov_b32 v[150:151], v[104:105], v[104:105]
    v_pk_mov_b32 v[152:153], v[104:105], v[104:105]
    v_pk_mov_b32 v[154:155], v[104:105], v[104:105]
    v_pk_mov_b32 v[156:157], v[104:105], v[104:105]
    v_pk_mov_b32 v[158:159], v[104:105], v[104:105]
    s_nop 1
    s_setpc_b64 s[76:77]
L_fb_B:
    s_lshl_b32 s72, s67, 16
    s_add_u32 s72, s72, 8388608
    s_lshl_b32 s69, s68, 3
    s_add_u32 s69, s69, s3
    s_sub_u32 s73, s69, s74
    s_mov_b32 s61, 0
    s_mov_b32 s76, 256
    s_call_b64 s[62:63], L_slow
    v_rcp_f32 v106, v236
    s_mov_b64 s[72:73], -1
    s_mov_b64 vcc, -1
    s_branch L_ok_B
L_fb_A:
    s_lshl_b32 s72, s67, 16
    s_add_u32 s72, s72, 2097152
    s_mov_b32 s73, 0
    s_mov_b32 s69, 63
    s_mov_b32 s61, 2048
    s_mov_b32 s76, 8192
    v_mov_b32 v176, v84
    v_mov_b32 v177, v85
    v_mov_b32 v178, v86
    v_mov_b32 v179, v87
    s_call_b64 s[62:63], L_slow
    v_mov_b32 v64, v228
    v_mov_b32 v65, v229
    v_mov_b32 v66, v230
    v_mov_b32 v67, v231
    v_mov_b32 v68, v232
    v_mov_b32 v69, v233
    v_mov_b32 v70, v234
    v_mov_b32 v71, v235
    v_mov_b32 v72, v236
    v_rcp_f32 v106, v236
    s_mov_b64 s[72:73], -1
    s_mov_b64 vcc, -1
    s_branch L_ok_A
L_slow:
    v_pk_mov_b32 v[248:249], 0, 0
    v_pk_mov_b32 v[250:251], 0, 0
    v_pk_mov_b32 v[252:253], 0, 0
    v_pk_mov_b32 v[254:255], 0, 0
    s_mov_b32 exec_lo, 0x00110000
    s_mov_b32 exec_hi, 0x00110000
    v_mov_b32 v248, 0x3f803f80
    v_mov_b32 v249, 0x3f803f80
    v_mov_b32 v250, 0x3f803f80
    v_mov_b32 v251, 0x3f803f80
    v_mov_b32 v252, 0x3f803f80
    v_mov_b32 v253, 0x3f803f80
    v_mov_b32 v254, 0x3f803f80
    v_mov_b32 v255, 0x3f803f80
    s_mov_b64 exec, -1
    v_mov_b32 v103, 4286578688
    v_mov_b32 v7, 4286578688
    s_lshl_b32 s6, s68, 3
    s_add_u32 s6, s6, s3
    s_lshl_b32 s6, s6, 5
    s_add_u32 s6, s6, s61
    v_and_b32 v4, 31, v1
    v_lshrrev_b32 v5, 5, v1
    v_lshlrev_b32 v5, 2, v5
    v_sub_u32 v4, v4, v5
    v_add_u32 v4, s6, v4
    s_mov_b32 s61, 0
L_slow_pass:
    s_mov_b32 s77, s73
L_slow_tile:
    s_lshl_b32 s6, s77, 10
    s_add_u32 s6, s6, s72
    s_add_u32 s7, s6, 2097152
    buffer_load_dwordx4 v[244:247], v180, s[8:11], s6 offen sc1
    s_mov_b64 exec, s[64:65]
    buffer_load_dwordx4 v[248:251], v181, s[8:11], s7 offen sc1
    buffer_load_dwordx4 v[252:255], v181, s[8:11], s7 offen offset:512 sc1
    s_mov_b64 exec, -1
    s_lshl_b32 s6, s77, 5
    v_subrev_u32 v5, s6, v4
    s_waitcnt vmcnt(0)
    v_mfma_f32_32x32x16_bf16 v[160:175], v[244:247], v[176:179], 0
    v_subrev_u32 v6, 0, v5
    v_cmp_gt_u32 vcc, s76, v6
    s_nop 9
    v_cndmask_b32 v160, v7, v160, vcc
    v_subrev_u32 v6, 1, v5
    v_cmp_gt_u32 vcc, s76, v6
    s_nop 1
    v_cndmask_b32 v161, v7, v161, vcc
    v_subrev_u32 v6, 2, v5
    v_cmp_gt_u32 vcc, s76, v6
    s_nop 1
    v_cndmask_b32 v162, v7, v162, vcc
    v_subrev_u32 v6, 3, v5
    v_cmp_gt_u32 vcc, s76, v6
    s_nop 1
    v_cndmask_b32 v163, v7, v163, vcc
    v_subrev_u32 v6, 8, v5
    v_cmp_gt_u32 vcc, s76, v6
    s_nop 1
    v_cndmask_b32 v164, v7, v164, vcc
    v_subrev_u32 v6, 9, v5
    v_cmp_gt_u32 vcc, s76, v6
    s_nop 1
    v_cndmask_b32 v165, v7, v165, vcc
    v_subrev_u32 v6, 10, v5
    v_cmp_gt_u32 vcc, s76, v6
    s_nop 1
    v_cndmask_b32 v166, v7, v166, vcc
    v_subrev_u32 v6, 11, v5
    v_cmp_gt_u32 vcc, s76, v6
    s_nop 1
    v_cndmask_b32 v167, v7, v167, vcc
    v_subrev_u32 v6, 16, v5
    v_cmp_gt_u32 vcc, s76, v6
    s_nop 1
    v_cndmask_b32 v168, v7, v168, vcc
    v_subrev_u32 v6, 17, v5
    v_cmp_gt_u32 vcc, s76, v6
    s_nop 1
    v_cndmask_b32 v169, v7, v169, vcc
    v_subrev_u32 v6, 18, v5
    v_cmp_gt_u32 vcc, s76, v6
    s_nop 1
    v_cndmask_b32 v170, v7, v170, vcc
    v_subrev_u32 v6, 19, v5
    v_cmp_gt_u32 vcc, s76, v6
    s_nop 1
    v_cndmask_b32 v171, v7, v171, vcc
    v_subrev_u32 v6, 24, v5
    v_cmp_gt_u32 vcc, s76, v6
    s_nop 1
    v_cndmask_b32 v172, v7, v172, vcc
    v_subrev_u32 v6, 25, v5
    v_cmp_gt_u32 vcc, s76, v6
    s_nop 1
    v_cndmask_b32 v173, v7, v173, vcc
    v_subrev_u32 v6, 26, v5
    v_cmp_gt_u32 vcc, s76, v6
    s_nop 1
    v_cndmask_b32 v174, v7, v174, vcc
    v_subrev_u32 v6, 27, v5
    v_cmp_gt_u32 vcc, s76, v6
    s_nop 1
    v_cndmask_b32 v175, v7, v175, vcc
    s_cmp_lg_u32 s61, 0
    s_cbranch_scc1 L_slow_exp
    v_max3_f32 v104, v160, v161, v162
    v_max3_f32 v105, v163, v164, v165
    v_max3_f32 v104, v104, v166, v167
    v_max3_f32 v105, v105, v168, v169
    v_max3_f32 v104, v104, v170, v171
    v_max3_f32 v105, v105, v172, v173
    v_max3_f32 v104, v104, v174, v175
    v_max_f32 v104, v104, v105
    v_max_f32 v103, v103, v104
    s_branch L_slow_next
L_slow_exp:
    v_add_f32 v160, v160, v106
    v_exp_f32 v160, v160
    v_add_f32 v161, v161, v106
    v_exp_f32 v161, v161
    v_add_f32 v162, v162, v106
    v_exp_f32 v162, v162
    v_add_f32 v163, v163, v106
    v_exp_f32 v163, v163
    v_add_f32 v164, v164, v106
    v_exp_f32 v164, v164
    v_add_f32 v165, v165, v106
    v_exp_f32 v165, v165
    v_add_f32 v166, v166, v106
    v_exp_f32 v166, v166
    v_add_f32 v167, v167, v106
    v_exp_f32 v167, v167
    v_add_f32 v168, v168, v106
    v_exp_f32 v168, v168
    v_add_f32 v169, v169, v106
    v_exp_f32 v169, v169
    v_add_f32 v170, v170, v106
    v_exp_f32 v170, v170
    v_add_f32 v171, v171, v106
    v_exp_f32 v171, v171
    v_add_f32 v172, v172, v106
    v_exp_f32 v172, v172
    v_add_f32 v173, v173, v106
    v_exp_f32 v173, v173
    v_add_f32 v174, v174, v106
    v_exp_f32 v174, v174
    v_add_f32 v175, v175, v106
    v_exp_f32 v175, v175
    v_smfmac_f32_32x32x32_bf16 v[228:243], v[248:251], v[160:167], v100
    s_nop 0
    v_smfmac_f32_32x32x32_bf16 v[228:243], v[252:255], v[168:175], v100
    s_nop 7
L_slow_next:
    s_add_u32 s77, s77, 1
    s_cmp_le_u32 s77, s69
    s_cbranch_scc1 L_slow_tile
    s_cmp_lg_u32 s61, 0
    s_cbranch_scc1 L_slow_ret
    v_mov_b32 v105, v103
    s_nop 1
    v_permlane32_swap_b32 v103, v105
    v_max_f32 v103, v103, v105
    v_sub_f32 v106, 0, v103
    v_sub_f32 v107, 0, v103
    v_pk_mov_b32 v[228:229], 0, 0
    v_pk_mov_b32 v[230:231], 0, 0
    v_pk_mov_b32 v[232:233], 0, 0
    v_pk_mov_b32 v[234:235], 0, 0
    v_pk_mov_b32 v[236:237], 0, 0
    v_pk_mov_b32 v[238:239], 0, 0
    v_pk_mov_b32 v[240:241], 0, 0
    v_pk_mov_b32 v[242:243], 0, 0
    s_mov_b32 s61, 1
    s_branch L_slow_pass
L_slow_ret:
    s_nop 15
    s_setpc_b64 s[62:63]
L_ob_late:
    s_mov_b32 s7, 0x40000
L_ob_poll:
    buffer_load_dwordx2 v[8:9], v195, s[8:11], s82 offen sc1
    s_waitcnt vmcnt(0)
    v_cmp_ne_u32 vcc, s85, v8
    s_cbranch_vccz L_ob_ok
    s_sleep 4
    s_sub_u32 s7, s7, 1
    s_cbranch_scc0 L_ob_poll
L_ob_ok:
    buffer_load_dwordx4 v[196:199], v180, s[8:11], s80 offen offset:0 sc1
    buffer_load_dwordx4 v[200:203], v180, s[8:11], s80 offen offset:1024 sc1
    buffer_load_dwordx4 v[204:207], v180, s[8:11], s80 offen offset:2048 sc1
    buffer_load_dwordx4 v[208:211], v180, s[8:11], s80 offen offset:3072 sc1
    buffer_load_dwordx4 v[212:215], v180, s[8:11], s75 offen offset:0 sc1
    buffer_load_dwordx4 v[216:219], v180, s[8:11], s75 offen offset:1024 sc1
    buffer_load_dwordx4 v[220:223], v180, s[8:11], s75 offen offset:2048 sc1
    buffer_load_dwordx4 v[224:227], v180, s[8:11], s75 offen offset:3072 sc1
    s_waitcnt vmcnt(0)
    s_branch L_ob_join
L_o_re00:
    s_sub_u32 s7, s7, 1
    s_cmp_eq_u32 s7, 0
    s_cselect_b32 s7, 1, s7
    s_cbranch_scc1 L_o_go00
    s_waitcnt vmcnt(0)
    s_sleep 4
    buffer_load_dwordx4 v[128:131], v180, s[8:11], s83 offen offset:0 sc1
    buffer_load_dwordx4 v[132:135], v180, s[8:11], s83 offen offset:1024 sc1
    buffer_load_dwordx4 v[136:139], v180, s[8:11], s83 offen offset:2048 sc1
    buffer_load_dwordx4 v[140:143], v180, s[8:11], s83 offen offset:3072 sc1
    buffer_load_dwordx4 v[144:147], v180, s[8:11], s84 offen offset:0 sc1
    buffer_load_dwordx4 v[148:151], v180, s[8:11], s84 offen offset:1024 sc1
    buffer_load_dwordx4 v[152:155], v180, s[8:11], s84 offen offset:2048 sc1
    buffer_load_dwordx4 v[156:159], v180, s[8:11], s84 offen offset:3072 sc1
    s_branch L_o_chk00
L_o_re01:
    s_sub_u32 s7, s7, 1
    s_cmp_eq_u32 s7, 0
    s_cselect_b32 s7, 1, s7
    s_cbranch_scc1 L_o_go01
    s_waitcnt vmcnt(0)
    s_sleep 4
    buffer_load_dwordx4 v[132:135], v180, s[8:11], s83 offen offset:1024 sc1
    buffer_load_dwordx4 v[136:139], v180, s[8:11], s83 offen offset:2048 sc1
    buffer_load_dwordx4 v[140:143], v180, s[8:11], s83 offen offset:3072 sc1
    buffer_load_dwordx4 v[144:147], v180, s[8:11], s84 offen offset:0 sc1
    buffer_load_dwordx4 v[148:151], v180, s[8:11], s84 offen offset:1024 sc1
    buffer_load_dwordx4 v[152:155], v180, s[8:11], s84 offen offset:2048 sc1
    buffer_load_dwordx4 v[156:159], v180, s[8:11], s84 offen offset:3072 sc1
    s_branch L_o_chk01
L_o_re02:
    s_sub_u32 s7, s7, 1
    s_cmp_eq_u32 s7, 0
    s_cselect_b32 s7, 1, s7
    s_cbranch_scc1 L_o_go02
    s_waitcnt vmcnt(0)
    s_sleep 4
    buffer_load_dwordx4 v[136:139], v180, s[8:11], s83 offen offset:2048 sc1
    buffer_load_dwordx4 v[140:143], v180, s[8:11], s83 offen offset:3072 sc1
    buffer_load_dwordx4 v[144:147], v180, s[8:11], s84 offen offset:0 sc1
    buffer_load_dwordx4 v[148:151], v180, s[8:11], s84 offen offset:1024 sc1
    buffer_load_dwordx4 v[152:155], v180, s[8:11], s84 offen offset:2048 sc1
    buffer_load_dwordx4 v[156:159], v180, s[8:11], s84 offen offset:3072 sc1
    s_branch L_o_chk02
L_o_re03:
    s_sub_u32 s7, s7, 1
    s_cmp_eq_u32 s7, 0
    s_cselect_b32 s7, 1, s7
    s_cbranch_scc1 L_o_go03
    s_waitcnt vmcnt(0)
    s_sleep 4
    buffer_load_dwordx4 v[140:143], v180, s[8:11], s83 offen offset:3072 sc1
    buffer_load_dwordx4 v[144:147], v180, s[8:11], s84 offen offset:0 sc1
    buffer_load_dwordx4 v[148:151], v180, s[8:11], s84 offen offset:1024 sc1
    buffer_load_dwordx4 v[152:155], v180, s[8:11], s84 offen offset:2048 sc1
    buffer_load_dwordx4 v[156:159], v180, s[8:11], s84 offen offset:3072 sc1
    s_branch L_o_chk03
L_o_re04:
    s_sub_u32 s7, s7, 1
    s_cmp_eq_u32 s7, 0
    s_cselect_b32 s7, 1, s7
    s_cbranch_scc1 L_o_go04
    s_waitcnt vmcnt(0)
    s_sleep 4
    buffer_load_dwordx4 v[144:147], v180, s[8:11], s84 offen offset:0 sc1
    buffer_load_dwordx4 v[148:151], v180, s[8:11], s84 offen offset:1024 sc1
    buffer_load_dwordx4 v[152:155], v180, s[8:11], s84 offen offset:2048 sc1
    buffer_load_dwordx4 v[156:159], v180, s[8:11], s84 offen offset:3072 sc1
    s_branch L_o_chk04
L_o_re05:
    s_sub_u32 s7, s7, 1
    s_cmp_eq_u32 s7, 0
    s_cselect_b32 s7, 1, s7
    s_cbranch_scc1 L_o_go05
    s_waitcnt vmcnt(0)
    s_sleep 4
    buffer_load_dwordx4 v[148:151], v180, s[8:11], s84 offen offset:1024 sc1
    buffer_load_dwordx4 v[152:155], v180, s[8:11], s84 offen offset:2048 sc1
    buffer_load_dwordx4 v[156:159], v180, s[8:11], s84 offen offset:3072 sc1
    s_branch L_o_chk05
L_o_re06:
    s_sub_u32 s7, s7, 1
    s_cmp_eq_u32 s7, 0
    s_cselect_b32 s7, 1, s7
    s_cbranch_scc1 L_o_go06
    s_waitcnt vmcnt(0)
    s_sleep 4
    buffer_load_dwordx4 v[152:155], v180, s[8:11], s84 offen offset:2048 sc1
    buffer_load_dwordx4 v[156:159], v180, s[8:11], s84 offen offset:3072 sc1
    s_branch L_o_chk06
L_o_re07:
    s_sub_u32 s7, s7, 1
    s_cmp_eq_u32 s7, 0
    s_cselect_b32 s7, 1, s7
    s_cbranch_scc1 L_o_go07
    s_waitcnt vmcnt(0)
    s_sleep 4
    buffer_load_dwordx4 v[156:159], v180, s[8:11], s84 offen offset:3072 sc1
    s_branch L_o_chk07
L_code_end:
.section .rodata,"a"
.p2align 6
.amdhsa_kernel gated_mix__mha_block__sliding_block__prompt_kernel
  .amdhsa_next_free_vgpr 256
  .amdhsa_next_free_sgpr 102
  .amdhsa_accum_offset 256
  .amdhsa_group_segment_fixed_size 0
  .amdhsa_kernarg_size 80
  .amdhsa_user_sgpr_count 2
  .amdhsa_user_sgpr_kernarg_segment_ptr 1
  .amdhsa_system_sgpr_workgroup_id_x 1
  .amdhsa_float_denorm_mode_32 3
.end_amdhsa_kernel
```
